```python
import torch

def _softmax(x, axis=-1):
    return torch.softmax(x, dim=axis)
def _gelu(x):
    return torch.nn.functional.gelu(x, approximate="tanh")
def _silu(x):
    return torch.nn.functional.silu(x)
def _sigmoid(x):
    return torch.sigmoid(x)
def _layernorm(x, axis=-1, eps=1e-5):
    m = x.mean(dim=axis, keepdim=True)
    v = x.var(dim=axis, keepdim=True, unbiased=False)
    return (x - m) / torch.sqrt(v + eps)
def _scatter_add(tgt, idx, src, axis=0):
    return tgt.clone().index_add_(axis, idx, src)
def _segment_sum(src, seg, n):
    out = torch.zeros((n,) + src.shape[1:], dtype=src.dtype)
    return out.index_add_(0, seg, src)
def _pad(x, pw):
    flat = tuple(v for pair in reversed(pw) for v in pair)
    return torch.nn.functional.pad(x, flat)

kernel_name = 'sequential_preLN__sliding_local_dilated__dense_activation_silu__prompt'

def setup_inputs():

    _w = (lambda a: (lambda t: t.to(torch.bfloat16) if t.is_floating_point() else t)(torch.as_tensor(a)))
    def _A_setup():
        B, S, D = 1, 2048, 1024
        return {
            "x": _w((lambda *s: torch.randn(*s, dtype=torch.bfloat16) * 0.05)(B, S, D)),
            "wqkv": _w((lambda *s: torch.randn(*s, dtype=torch.bfloat16) * 0.05)(D, 3 * D)),
            "wo": _w((lambda *s: torch.randn(*s, dtype=torch.bfloat16) * 0.05)(D, D)),
        }
    _A_in = _A_setup()

    def _B_setup():
        B, S, D, F = 1, 2048, 1024, 3584
        return {
            "x": _w((lambda *s: torch.randn(*s, dtype=torch.bfloat16) * 0.05)(B, S, D)),
            "w1": _w((lambda *s: torch.randn(*s, dtype=torch.bfloat16) * 3.2)(D, F) * (D ** -0.5)),
            "w2": _w((lambda *s: torch.randn(*s, dtype=torch.bfloat16) * 0.4)(F, D) * (F ** -0.5)),
        }
    _B_in = _B_setup()

    return {
        "A_x": _A_in["x"],
        "A_wqkv": _A_in["wqkv"],
        "A_wo": _A_in["wo"],
        "B_x": _B_in["x"],
        "B_w1": _B_in["w1"],
        "B_w2": _B_in["w2"],
    }

def reference(A_x, A_wqkv, A_wo, B_x, B_w1, B_w2):
    def _A_ref(x, wqkv, wo):
        B, S, D = x.shape
        H = 32; Dh = D // H
        W, dil = 8, 2
        qkv = (lambda x, *d: x.permute(*d))((x @ wqkv).reshape(B, S, 3, H, Dh), 2, 0, 3, 1, 4)
        q, k, v = qkv[0], qkv[1], qkv[2]
        scale = Dh ** -0.5
        pos = torch.arange(S)
        off = torch.arange(W) * dil
        idx = pos[:, None] - off[None, :]
        mask = idx >= 0
        idx_c = torch.where(mask, idx, 0).reshape(-1)
        kg = k[:, :, idx_c, :].reshape(B, H, S, W, Dh)
        vg = v[:, :, idx_c, :].reshape(B, H, S, W, Dh)
        logits = torch.einsum("bhsd,bhswd->bhsw", q, kg) * scale
        logits = torch.where(mask[None, None, :, :], logits, -1e9)
        attn = _softmax(logits, axis=-1)
        o = torch.einsum("bhsw,bhswd->bhsd", attn, vg)
        return (lambda x, *d: x.permute(*d))(o, 0, 2, 1, 3).reshape(B, S, D) @ wo

    def _B_ref(x, w1, w2):
        h = torch.einsum("bsd,df->bsf", x, w1)
        h = _silu(h)
        out = torch.einsum("bsf,fd->bsd", h, w2)
        return out

    x = A_x
    h = x + _A_ref(_layernorm(x, axis=-1), A_wqkv, A_wo)
    h2 = h + _B_ref(_layernorm(h, axis=-1), B_w1, B_w2)
    return h2
```

```asm
; @launch grid=(256,1,1) block=(512,1,1) lds=163840
.amdgcn_target "amdgcn-amd-amdhsa--gfx950"
.text
.globl sequential_preLN__sliding_local_dilated__dense_activation_silu__prompt_kernel
.p2align 8
.type sequential_preLN__sliding_local_dilated__dense_activation_silu__prompt_kernel,@function
sequential_preLN__sliding_local_dilated__dense_activation_silu__prompt_kernel:
    s_cmp_ge_u32 s2, 256
    s_cbranch_scc1 sequential_preLN__sliding_local_dilated__dense_activation_silu__prompt_kernel_end
    s_load_dwordx16 s[76:91], s[0:1], 0
    s_load_dwordx2 s[92:93], s[0:1], 64
    v_lshrrev_b32 v1, 6, v0
    s_and_b32 s34, s2, 7
    s_lshr_b32 s35, s2, 3
    s_lshr_b32 s39, s35, 2
    s_and_b32 s54, s35, 3
    s_lshr_b32 s36, s34, 2
    s_and_b32 s37, s34, 3
    s_lshl_b32 s25, s36, 3
    s_lshl_b32 s26, s37, 2
    s_add_u32 s25, s25, s39
    s_add_u32 s26, s26, s54
    v_readfirstlane_b32 s24, v1
    v_and_b32 v1, 63, v0
    s_cmp_ge_u32 s24, 4
    s_cbranch_scc1 sequential_preLN__sliding_local_dilated__dense_activation_silu__prompt_kernel_loader
p1_c:
    s_lshr_b32 s27, s24, 1
    s_and_b32 s28, s24, 1
    s_setprio 3
    s_waitcnt lgkmcnt(0)
    s_mov_b32 s16, s76
    s_mov_b32 s17, s77
    s_mov_b32 s18, 0x400000
    s_mov_b32 s19, 0x20000
    s_lshl_b32 s42, s2, 2
    s_add_u32 s42, s42, s24
    s_lshl_b32 s41, s42, 12
    s_lshl_b32 s42, s42, 4
    v_lshlrev_b32 v144, 4, v1
    buffer_load_dwordx4 v[128:131], v144, s[16:19], s41 offen offset:0
    buffer_load_dwordx4 v[132:135], v144, s[16:19], s41 offen offset:1024
    buffer_load_dwordx4 v[136:139], v144, s[16:19], s41 offen offset:2048
    buffer_load_dwordx4 v[140:143], v144, s[16:19], s41 offen offset:3072
    s_setprio 0
    v_and_b32 v16, 15, v1
    v_lshrrev_b32 v17, 4, v1
    v_bfe_u32 v18, v16, 1, 3
    v_xor_b32 v18, v18, v17
    v_lshlrev_b32 v18, 4, v18
    v_lshl_add_u32 v19, v16, 7, v18
    s_mul_i32 s34, s27, 8192
    s_add_u32 s34, s34, 2048
    v_add_u32 v2, s34, v19
    v_xor_b32 v3, 64, v2
    s_mov_b32 s34, 0
    v_add_u32 v4, s34, v19
    v_xor_b32 v5, 64, v4
    v_bfe_u32 v18, v1, 2, 2
    v_lshl_add_u32 v18, v17, 3, v18
    v_bfe_u32 v19, v1, 1, 1
    v_and_b32 v20, 1, v1
    v_lshlrev_b32 v20, 3, v20
    v_bfe_u32 v21, v1, 3, 2
    v_lshlrev_b32 v21, 1, v21
    v_xor_b32 v21, v21, v19
    v_lshl_add_u32 v21, v21, 4, v20
    v_lshl_add_u32 v21, v18, 7, v21
    s_lshl_b32 s34, s28, 1
    s_add_u32 s34, s34, s27
    s_lshl_b32 s34, s34, 5
    v_xor_b32 v6, s34, v21
    v_add_u32 v6, 18432, v6
    s_lshl_b32 s34, s28, 1
    s_add_u32 s34, s34, s27
    s_xor_b32 s34, s34, 1
    s_lshl_b32 s34, s34, 5
    v_xor_b32 v7, s34, v21
    v_add_u32 v7, 18432, v7
    s_add_u32 s12, s92, 0x400000
    s_addc_u32 s13, s93, 0
    s_mov_b32 s14, 0x400000
    s_mov_b32 s15, 0x20000
    v_and_b32 v12, 15, v1
    v_lshrrev_b32 v13, 4, v1
    v_lshlrev_b32 v14, 2, v13
    v_sub_u32 v14, v12, v14
    s_mov_b32 s34, 0xf149f2ca
    v_mov_b32 v12, s34
    v_add_u32 v13, 16, v14
    v_and_b32 v13, 0xfffffff1, v13
    v_cmp_ne_u32 vcc, 0, v13
    s_nop 1
    v_cndmask_b32 v148, 0, v12, vcc
    v_add_u32 v13, 15, v14
    v_and_b32 v13, 0xfffffff1, v13
    v_cmp_ne_u32 vcc, 0, v13
    s_nop 1
    v_cndmask_b32 v149, 0, v12, vcc
    v_add_u32 v13, 14, v14
    v_and_b32 v13, 0xfffffff1, v13
    v_cmp_ne_u32 vcc, 0, v13
    s_nop 1
    v_cndmask_b32 v150, 0, v12, vcc
    v_add_u32 v13, 13, v14
    v_and_b32 v13, 0xfffffff1, v13
    v_cmp_ne_u32 vcc, 0, v13
    s_nop 1
    v_cndmask_b32 v151, 0, v12, vcc
    v_add_u32 v13, 0, v14
    v_and_b32 v13, 0xfffffff1, v13
    v_cmp_ne_u32 vcc, 0, v13
    s_nop 1
    v_cndmask_b32 v152, 0, v12, vcc
    v_add_u32 v13, -1, v14
    v_and_b32 v13, 0xfffffff1, v13
    v_cmp_ne_u32 vcc, 0, v13
    s_nop 1
    v_cndmask_b32 v153, 0, v12, vcc
    v_add_u32 v13, -2, v14
    v_and_b32 v13, 0xfffffff1, v13
    v_cmp_ne_u32 vcc, 0, v13
    s_nop 1
    v_cndmask_b32 v154, 0, v12, vcc
    v_add_u32 v13, -3, v14
    v_and_b32 v13, 0xfffffff1, v13
    v_cmp_ne_u32 vcc, 0, v13
    s_nop 1
    v_cndmask_b32 v155, 0, v12, vcc
    s_or_b32 s35, s25, s27
    s_cmp_eq_u32 s35, 0
    s_cselect_b32 s35, s34, 0
    v_add_f32 v156, s35, v148
    v_add_f32 v157, s35, v149
    v_add_f32 v158, s35, v150
    v_add_f32 v159, s35, v151
    v_lshlrev_b32 v12, 4, v1
    s_mul_i32 s34, s24, 6144
    s_add_u32 s34, s34, 98304
    s_xor_b32 s35, s24, 2
    s_mul_i32 s35, s35, 6144
    s_add_u32 s35, s35, 98304
    v_add_u32 v160, s34, v12
    s_cmp_eq_u32 s27, 0
    s_add_u32 s40, s34, 0
    s_add_u32 s41, s35, 3072
    s_cmp_eq_u32 s27, 0
    s_cselect_b32 s40, s40, s41
    v_add_u32 v161, s40, v12
    s_add_u32 s40, s35, 0
    s_add_u32 s41, s35, 2048
    s_cmp_eq_u32 s27, 0
    s_cselect_b32 s40, s40, s41
    v_add_u32 v162, s40, v12
    s_add_u32 s40, s34, 1024
    s_add_u32 s41, s35, 5120
    s_cmp_eq_u32 s27, 0
    s_cselect_b32 s40, s40, s41
    v_add_u32 v163, s40, v12
    s_add_u32 s40, s35, 1024
    s_add_u32 s41, s35, 4096
    s_cmp_eq_u32 s27, 0
    s_cselect_b32 s40, s40, s41
    v_add_u32 v164, s40, v12
    s_lshl_b32 s34, s28, 7
    s_lshl_b32 s35, s27, 6
    s_add_u32 s34, s34, s35
    s_add_u32 s34, s34, 130176
    v_lshrrev_b32 v13, 4, v1
    v_lshlrev_b32 v13, 4, v13
    v_add_u32 v165, s34, v13
    v_and_b32 v13, 15, v1
    v_lshlrev_b32 v13, 2, v13
    v_add_u32 v166, s34, v13
    v_mov_b64 v[16:17], 0
    v_mov_b64 v[18:19], 0
    v_mov_b64 v[20:21], 0
    v_mov_b64 v[22:23], 0
    v_mov_b64 v[24:25], 0
    v_mov_b64 v[26:27], 0
    v_mov_b64 v[28:29], 0
    v_mov_b64 v[30:31], 0
    v_mov_b64 v[32:33], 0
    v_mov_b64 v[34:35], 0
    v_mov_b64 v[36:37], 0
    v_mov_b64 v[38:39], 0
    v_mov_b64 v[40:41], 0
    v_mov_b64 v[42:43], 0
    v_mov_b64 v[44:45], 0
    v_mov_b64 v[46:47], 0
    v_mov_b64 v[48:49], 0
    v_mov_b64 v[50:51], 0
    v_mov_b64 v[52:53], 0
    v_mov_b64 v[54:55], 0
    v_mov_b64 v[56:57], 0
    v_mov_b64 v[58:59], 0
    v_mov_b64 v[60:61], 0
    v_mov_b64 v[62:63], 0
    v_mov_b64 v[64:65], 0
    v_mov_b64 v[66:67], 0
    v_mov_b64 v[68:69], 0
    v_mov_b64 v[70:71], 0
    v_mov_b64 v[72:73], 0
    v_mov_b64 v[74:75], 0
    v_mov_b64 v[76:77], 0
    v_mov_b64 v[78:79], 0
    v_mov_b64 v[80:81], 0
    v_mov_b64 v[82:83], 0
    v_mov_b64 v[84:85], 0
    v_mov_b64 v[86:87], 0
    v_mov_b64 v[88:89], 0
    v_mov_b64 v[90:91], 0
    v_mov_b64 v[92:93], 0
    v_mov_b64 v[94:95], 0
    v_mov_b64 v[96:97], 0
    v_mov_b64 v[98:99], 0
    v_mov_b64 v[100:101], 0
    v_mov_b64 v[102:103], 0
    v_mov_b64 v[104:105], 0
    v_mov_b64 v[106:107], 0
    v_mov_b64 v[108:109], 0
    v_mov_b64 v[110:111], 0
    v_mov_b64 v[112:113], 0
    v_mov_b64 v[114:115], 0
    v_mov_b64 v[116:117], 0
    v_mov_b64 v[118:119], 0
    v_mov_b64 v[120:121], 0
    v_mov_b64 v[122:123], 0
    s_mov_b32 s32, 0
    s_mov_b32 s36, 43008
    s_mov_b32 s37, 4294881280
    s_setprio 3
    s_mov_b32 s62, 13
    s_barrier
    ds_read_b128 a[0:3], v4 offset:0
    ds_read_b128 a[4:7], v2 offset:0
    ds_read_b128 a[8:11], v2 offset:2048
    ds_read_b128 a[12:15], v2 offset:4096
    ds_read_b128 a[16:19], v2 offset:6144
    ds_read_b64_tr_b16 a[20:21], v6 offset:0
    ds_read_b64_tr_b16 a[22:23], v6 offset:512
    ds_read_b64_tr_b16 a[24:25], v7 offset:0
    ds_read_b64_tr_b16 a[26:27], v7 offset:512
    ds_read_b64_tr_b16 a[28:29], v6 offset:8192
    ds_read_b64_tr_b16 a[30:31], v6 offset:8704
    ds_read_b64_tr_b16 a[32:33], v7 offset:8192
    ds_read_b64_tr_b16 a[34:35], v7 offset:8704
    ds_read_b64_tr_b16 a[36:37], v6 offset:16384
    ds_read_b64_tr_b16 a[38:39], v6 offset:16896
    ds_read_b64_tr_b16 a[40:41], v7 offset:16384
    ds_read_b64_tr_b16 a[42:43], v7 offset:16896
    s_mov_b32 s31, 16
Lc_1:
    s_waitcnt lgkmcnt(0)
    v_mfma_f32_16x16x32_bf16 v[16:19], a[20:23], a[0:3], v[16:19]
    ds_read_b128 a[44:47], v5 offset:0
    v_mfma_f32_16x16x32_bf16 v[20:23], a[20:23], a[4:7], v[20:23]
    ds_read_b128 a[48:51], v3 offset:0
    v_mfma_f32_16x16x32_bf16 v[24:27], a[20:23], a[8:11], v[24:27]
    ds_read_b128 a[52:55], v3 offset:2048
    v_mfma_f32_16x16x32_bf16 v[28:31], a[20:23], a[12:15], v[28:31]
    ds_read_b128 a[56:59], v3 offset:4096
    v_mfma_f32_16x16x32_bf16 v[32:35], a[20:23], a[16:19], v[32:35]
    ds_read_b128 a[60:63], v3 offset:6144
    v_mfma_f32_16x16x32_bf16 v[36:39], a[24:27], a[4:7], v[36:39]
    ds_read_b64_tr_b16 a[64:65], v6 offset:4096
    v_mfma_f32_16x16x32_bf16 v[40:43], a[24:27], a[8:11], v[40:43]
    ds_read_b64_tr_b16 a[66:67], v6 offset:4608
    v_mfma_f32_16x16x32_bf16 v[44:47], a[24:27], a[12:15], v[44:47]
    ds_read_b64_tr_b16 a[68:69], v7 offset:4096
    v_mfma_f32_16x16x32_bf16 v[48:51], a[24:27], a[16:19], v[48:51]
    ds_read_b64_tr_b16 a[70:71], v7 offset:4608
    v_mfma_f32_16x16x32_bf16 v[52:55], a[28:31], a[0:3], v[52:55]
    ds_read_b64_tr_b16 a[72:73], v6 offset:12288
    v_mfma_f32_16x16x32_bf16 v[56:59], a[28:31], a[4:7], v[56:59]
    ds_read_b64_tr_b16 a[74:75], v6 offset:12800
    v_mfma_f32_16x16x32_bf16 v[60:63], a[28:31], a[8:11], v[60:63]
    ds_read_b64_tr_b16 a[76:77], v7 offset:12288
    v_mfma_f32_16x16x32_bf16 v[64:67], a[28:31], a[12:15], v[64:67]
    ds_read_b64_tr_b16 a[78:79], v7 offset:12800
    v_mfma_f32_16x16x32_bf16 v[68:71], a[28:31], a[16:19], v[68:71]
    ds_read_b64_tr_b16 a[80:81], v6 offset:20480
    v_mfma_f32_16x16x32_bf16 v[72:75], a[32:35], a[4:7], v[72:75]
    ds_read_b64_tr_b16 a[82:83], v6 offset:20992
    v_mfma_f32_16x16x32_bf16 v[76:79], a[32:35], a[8:11], v[76:79]
    ds_read_b64_tr_b16 a[84:85], v7 offset:20480
    v_mfma_f32_16x16x32_bf16 v[80:83], a[32:35], a[12:15], v[80:83]
    ds_read_b64_tr_b16 a[86:87], v7 offset:20992
    v_mfma_f32_16x16x32_bf16 v[84:87], a[32:35], a[16:19], v[84:87]
    s_add_u32 s32, s32, 43008
    v_mfma_f32_16x16x32_bf16 v[88:91], a[0:3], a[36:39], v[88:91]
    s_cmp_eq_u32 s32, 129024
    v_mfma_f32_16x16x32_bf16 v[92:95], a[4:7], a[36:39], v[92:95]
    s_cselect_b32 s33, s37, s36
    v_mfma_f32_16x16x32_bf16 v[96:99], a[8:11], a[36:39], v[96:99]
    s_cselect_b32 s32, 0, s32
    v_mfma_f32_16x16x32_bf16 v[100:103], a[12:15], a[36:39], v[100:103]
    v_add_u32 v2, s33, v2
    v_mfma_f32_16x16x32_bf16 v[104:107], a[16:19], a[36:39], v[104:107]
    v_add_u32 v4, s33, v4
    v_mfma_f32_16x16x32_bf16 v[108:111], a[4:7], a[40:43], v[108:111]
    v_add_u32 v6, s33, v6
    v_mfma_f32_16x16x32_bf16 v[112:115], a[8:11], a[40:43], v[112:115]
    v_add_u32 v7, s33, v7
    v_mfma_f32_16x16x32_bf16 v[116:119], a[12:15], a[40:43], v[116:119]
    v_mfma_f32_16x16x32_bf16 v[120:123], a[16:19], a[40:43], v[120:123]
    s_cmp_eq_u32 s31, 16
    s_cbranch_scc1 Lha_4
Lhb_5:
    s_waitcnt lgkmcnt(0)
    s_barrier
    v_mfma_f32_16x16x32_bf16 v[16:19], a[64:67], a[44:47], v[16:19]
    ds_read_b128 a[0:3], v4 offset:0
    v_mfma_f32_16x16x32_bf16 v[20:23], a[64:67], a[48:51], v[20:23]
    ds_read_b128 a[4:7], v2 offset:0
    v_mfma_f32_16x16x32_bf16 v[24:27], a[64:67], a[52:55], v[24:27]
    ds_read_b128 a[8:11], v2 offset:2048
    v_mfma_f32_16x16x32_bf16 v[28:31], a[64:67], a[56:59], v[28:31]
    ds_read_b128 a[12:15], v2 offset:4096
    v_mfma_f32_16x16x32_bf16 v[32:35], a[64:67], a[60:63], v[32:35]
    ds_read_b128 a[16:19], v2 offset:6144
    v_mfma_f32_16x16x32_bf16 v[36:39], a[68:71], a[48:51], v[36:39]
    ds_read_b64_tr_b16 a[20:21], v6 offset:0
    v_mfma_f32_16x16x32_bf16 v[40:43], a[68:71], a[52:55], v[40:43]
    ds_read_b64_tr_b16 a[22:23], v6 offset:512
    v_mfma_f32_16x16x32_bf16 v[44:47], a[68:71], a[56:59], v[44:47]
    ds_read_b64_tr_b16 a[24:25], v7 offset:0
    v_mfma_f32_16x16x32_bf16 v[48:51], a[68:71], a[60:63], v[48:51]
    ds_read_b64_tr_b16 a[26:27], v7 offset:512
    v_mfma_f32_16x16x32_bf16 v[52:55], a[72:75], a[44:47], v[52:55]
    ds_read_b64_tr_b16 a[28:29], v6 offset:8192
    v_mfma_f32_16x16x32_bf16 v[56:59], a[72:75], a[48:51], v[56:59]
    ds_read_b64_tr_b16 a[30:31], v6 offset:8704
    v_mfma_f32_16x16x32_bf16 v[60:63], a[72:75], a[52:55], v[60:63]
    ds_read_b64_tr_b16 a[32:33], v7 offset:8192
    v_mfma_f32_16x16x32_bf16 v[64:67], a[72:75], a[56:59], v[64:67]
    ds_read_b64_tr_b16 a[34:35], v7 offset:8704
    v_mfma_f32_16x16x32_bf16 v[68:71], a[72:75], a[60:63], v[68:71]
    ds_read_b64_tr_b16 a[36:37], v6 offset:16384
    v_mfma_f32_16x16x32_bf16 v[72:75], a[76:79], a[48:51], v[72:75]
    ds_read_b64_tr_b16 a[38:39], v6 offset:16896
    v_mfma_f32_16x16x32_bf16 v[76:79], a[76:79], a[52:55], v[76:79]
    ds_read_b64_tr_b16 a[40:41], v7 offset:16384
    v_mfma_f32_16x16x32_bf16 v[80:83], a[76:79], a[56:59], v[80:83]
    ds_read_b64_tr_b16 a[42:43], v7 offset:16896
    v_mfma_f32_16x16x32_bf16 v[84:87], a[76:79], a[60:63], v[84:87]
    v_add_u32 v3, s33, v3
    v_mfma_f32_16x16x32_bf16 v[88:91], a[44:47], a[80:83], v[88:91]
    v_add_u32 v5, s33, v5
    v_mfma_f32_16x16x32_bf16 v[92:95], a[48:51], a[80:83], v[92:95]
    s_cmp_eq_u32 s31, s62
    s_cbranch_scc1 Lfg_2
Lfb_3:
    v_mfma_f32_16x16x32_bf16 v[96:99], a[52:55], a[80:83], v[96:99]
    s_sub_u32 s31, s31, 1
    v_mfma_f32_16x16x32_bf16 v[100:103], a[56:59], a[80:83], v[100:103]
    s_cmp_lg_u32 s31, 12
    v_mfma_f32_16x16x32_bf16 v[104:107], a[60:63], a[80:83], v[104:107]
    v_mfma_f32_16x16x32_bf16 v[108:111], a[48:51], a[84:87], v[108:111]
    v_mfma_f32_16x16x32_bf16 v[112:115], a[52:55], a[84:87], v[112:115]
    v_mfma_f32_16x16x32_bf16 v[116:119], a[56:59], a[84:87], v[116:119]
    v_mfma_f32_16x16x32_bf16 v[120:123], a[60:63], a[84:87], v[120:123]
    s_cbranch_scc1 Lc_1
Lc_6:
    s_waitcnt lgkmcnt(0)
    v_mfma_f32_16x16x32_bf16 v[16:19], a[20:23], a[0:3], v[16:19]
    ds_read_b128 a[44:47], v5 offset:0
    v_mfma_f32_16x16x32_bf16 v[20:23], a[20:23], a[4:7], v[20:23]
    ds_read_b128 a[48:51], v3 offset:0
    v_mfma_f32_16x16x32_bf16 v[24:27], a[20:23], a[8:11], v[24:27]
    ds_read_b128 a[52:55], v3 offset:2048
    v_mfma_f32_16x16x32_bf16 v[28:31], a[20:23], a[12:15], v[28:31]
    ds_read_b128 a[56:59], v3 offset:4096
    v_mfma_f32_16x16x32_bf16 v[32:35], a[20:23], a[16:19], v[32:35]
    ds_read_b128 a[60:63], v3 offset:6144
    v_mfma_f32_16x16x32_bf16 v[36:39], a[24:27], a[4:7], v[36:39]
    ds_read_b64_tr_b16 a[64:65], v6 offset:4096
    v_mfma_f32_16x16x32_bf16 v[40:43], a[24:27], a[8:11], v[40:43]
    ds_read_b64_tr_b16 a[66:67], v6 offset:4608
    v_mfma_f32_16x16x32_bf16 v[44:47], a[24:27], a[12:15], v[44:47]
    ds_read_b64_tr_b16 a[68:69], v7 offset:4096
    v_mfma_f32_16x16x32_bf16 v[48:51], a[24:27], a[16:19], v[48:51]
    ds_read_b64_tr_b16 a[70:71], v7 offset:4608
    v_mfma_f32_16x16x32_bf16 v[52:55], a[28:31], a[0:3], v[52:55]
    ds_read_b64_tr_b16 a[72:73], v6 offset:12288
    v_mfma_f32_16x16x32_bf16 v[56:59], a[28:31], a[4:7], v[56:59]
    ds_read_b64_tr_b16 a[74:75], v6 offset:12800
    v_mfma_f32_16x16x32_bf16 v[60:63], a[28:31], a[8:11], v[60:63]
    ds_read_b64_tr_b16 a[76:77], v7 offset:12288
    v_mfma_f32_16x16x32_bf16 v[64:67], a[28:31], a[12:15], v[64:67]
    ds_read_b64_tr_b16 a[78:79], v7 offset:12800
    v_mfma_f32_16x16x32_bf16 v[68:71], a[28:31], a[16:19], v[68:71]
    ds_read_b64_tr_b16 a[80:81], v6 offset:20480
    v_mfma_f32_16x16x32_bf16 v[72:75], a[32:35], a[4:7], v[72:75]
    ds_read_b64_tr_b16 a[82:83], v6 offset:20992
    v_mfma_f32_16x16x32_bf16 v[76:79], a[32:35], a[8:11], v[76:79]
    ds_read_b64_tr_b16 a[84:85], v7 offset:20480
    v_mfma_f32_16x16x32_bf16 v[80:83], a[32:35], a[12:15], v[80:83]
    ds_read_b64_tr_b16 a[86:87], v7 offset:20992
    v_mfma_f32_16x16x32_bf16 v[84:87], a[32:35], a[16:19], v[84:87]
    s_add_u32 s32, s32, 43008
    v_mfma_f32_16x16x32_bf16 v[88:91], a[0:3], a[36:39], v[88:91]
    s_cmp_eq_u32 s32, 129024
    v_mfma_f32_16x16x32_bf16 v[92:95], a[4:7], a[36:39], v[92:95]
    s_cselect_b32 s33, s37, s36
    v_mfma_f32_16x16x32_bf16 v[96:99], a[8:11], a[36:39], v[96:99]
    s_cselect_b32 s32, 0, s32
    v_mfma_f32_16x16x32_bf16 v[100:103], a[12:15], a[36:39], v[100:103]
    v_add_u32 v2, s33, v2
    v_mfma_f32_16x16x32_bf16 v[104:107], a[16:19], a[36:39], v[104:107]
    v_add_u32 v4, s33, v4
    v_mfma_f32_16x16x32_bf16 v[108:111], a[4:7], a[40:43], v[108:111]
    v_add_u32 v6, s33, v6
    v_mfma_f32_16x16x32_bf16 v[112:115], a[8:11], a[40:43], v[112:115]
    v_add_u32 v7, s33, v7
    v_mfma_f32_16x16x32_bf16 v[116:119], a[12:15], a[40:43], v[116:119]
    v_mfma_f32_16x16x32_bf16 v[120:123], a[16:19], a[40:43], v[120:123]
    s_waitcnt lgkmcnt(0)
    s_barrier
    v_mfma_f32_16x16x32_bf16 v[16:19], a[64:67], a[44:47], v[16:19]
    ds_read_b128 a[0:3], v4 offset:0
    v_mfma_f32_16x16x32_bf16 v[20:23], a[64:67], a[48:51], v[20:23]
    ds_read_b128 a[4:7], v2 offset:0
    v_mfma_f32_16x16x32_bf16 v[24:27], a[64:67], a[52:55], v[24:27]
    ds_read_b128 a[8:11], v2 offset:2048
    v_mfma_f32_16x16x32_bf16 v[28:31], a[64:67], a[56:59], v[28:31]
    ds_read_b128 a[12:15], v2 offset:4096
    v_mfma_f32_16x16x32_bf16 v[32:35], a[64:67], a[60:63], v[32:35]
    ds_read_b128 a[16:19], v2 offset:6144
    v_mfma_f32_16x16x32_bf16 v[36:39], a[68:71], a[48:51], v[36:39]
    ds_read_b64_tr_b16 a[20:21], v6 offset:0
    v_mfma_f32_16x16x32_bf16 v[40:43], a[68:71], a[52:55], v[40:43]
    ds_read_b64_tr_b16 a[22:23], v6 offset:512
    v_mfma_f32_16x16x32_bf16 v[44:47], a[68:71], a[56:59], v[44:47]
    ds_read_b64_tr_b16 a[24:25], v7 offset:0
    v_mfma_f32_16x16x32_bf16 v[48:51], a[68:71], a[60:63], v[48:51]
    ds_read_b64_tr_b16 a[26:27], v7 offset:512
    v_mfma_f32_16x16x32_bf16 v[52:55], a[72:75], a[44:47], v[52:55]
    ds_read_b64_tr_b16 a[28:29], v6 offset:8192
    v_mfma_f32_16x16x32_bf16 v[56:59], a[72:75], a[48:51], v[56:59]
    ds_read_b64_tr_b16 a[30:31], v6 offset:8704
    v_mfma_f32_16x16x32_bf16 v[60:63], a[72:75], a[52:55], v[60:63]
    ds_read_b64_tr_b16 a[32:33], v7 offset:8192
    v_mfma_f32_16x16x32_bf16 v[64:67], a[72:75], a[56:59], v[64:67]
    ds_read_b64_tr_b16 a[34:35], v7 offset:8704
    v_mfma_f32_16x16x32_bf16 v[68:71], a[72:75], a[60:63], v[68:71]
    ds_read_b64_tr_b16 a[36:37], v6 offset:16384
    v_mfma_f32_16x16x32_bf16 v[72:75], a[76:79], a[48:51], v[72:75]
    ds_read_b64_tr_b16 a[38:39], v6 offset:16896
    v_mfma_f32_16x16x32_bf16 v[76:79], a[76:79], a[52:55], v[76:79]
    ds_read_b64_tr_b16 a[40:41], v7 offset:16384
    v_mfma_f32_16x16x32_bf16 v[80:83], a[76:79], a[56:59], v[80:83]
    ds_read_b64_tr_b16 a[42:43], v7 offset:16896
    v_mfma_f32_16x16x32_bf16 v[84:87], a[76:79], a[60:63], v[84:87]
    v_add_u32 v3, s33, v3
    v_mfma_f32_16x16x32_bf16 v[88:91], a[44:47], a[80:83], v[88:91]
    v_add_u32 v5, s33, v5
    v_mfma_f32_16x16x32_bf16 v[92:95], a[48:51], a[80:83], v[92:95]
    s_sub_u32 s31, s31, 1
    v_mfma_f32_16x16x32_bf16 v[96:99], a[52:55], a[80:83], v[96:99]
    s_cmp_lg_u32 s31, 0
    v_mfma_f32_16x16x32_bf16 v[100:103], a[56:59], a[80:83], v[100:103]
    v_mfma_f32_16x16x32_bf16 v[104:107], a[60:63], a[80:83], v[104:107]
    v_mfma_f32_16x16x32_bf16 v[108:111], a[48:51], a[84:87], v[108:111]
    v_mfma_f32_16x16x32_bf16 v[112:115], a[52:55], a[84:87], v[112:115]
    v_mfma_f32_16x16x32_bf16 v[116:119], a[56:59], a[84:87], v[116:119]
    v_mfma_f32_16x16x32_bf16 v[120:123], a[60:63], a[84:87], v[120:123]
    s_cbranch_scc1 Lc_6
    s_waitcnt lgkmcnt(0)
    s_setprio 0
    s_nop 7
p1_epi:
    ds_write_b128 v160, v[52:55] offset:0
    ds_write_b128 v160, v[88:91] offset:1024
    ds_write_b128 v160, v[68:71] offset:2048
    ds_write_b128 v160, v[84:87] offset:3072
    ds_write_b128 v160, v[104:107] offset:4096
    ds_write_b128 v160, v[120:123] offset:5120
    s_mov_b32 exec_lo, 0x10001
    s_mov_b32 exec_hi, 0x10001
    ds_write_b128 v165, v[16:19]
    ds_write_b128 v165, v[52:55] offset:256
    s_mov_b64 exec, 0xffff
    ds_write_b32 v166, v88 offset:512
    s_mov_b64 exec, -1
    v_and_b32 v2, 15, v1
    v_lshrrev_b32 v3, 4, v1
    s_lshl_b32 s34, s27, 8
    s_add_u32 s34, s34, 129024
    v_lshlrev_b32 v4, 2, v2
    v_add_u32 v4, s34, v4
    v_lshlrev_b32 v5, 4, v3
    v_add_u32 v5, s34, v5
    v_xor_b32 v6, 64, v165
    v_xor_b32 v7, 64, v166
    ds_read2_b32 v[130:131], v4 offset0:16 offset1:160
    ds_read2_b32 v[132:133], v4 offset0:32 offset1:176
    ds_read2_b32 v[134:135], v4 offset0:48 offset1:192
    ds_read2_b32 v[136:137], v4 offset0:64 offset1:208
    ds_read2_b32 v[128:129], v4 offset0:0 offset1:144
    ds_read_b128 v[8:11], v5 offset:0
    ds_read_b128 v[12:15], v5 offset:576
    s_waitcnt lgkmcnt(7)
    s_barrier
    ds_read_b128 v[140:143], v165
    ds_read_b128 v[144:147], v6
    ds_read_b128 v[52:55], v161
    ds_read_b128 v[16:19], v162
    ds_read_b128 v[88:91], v163
    ds_read_b128 v[124:127], v164
    ds_read_b32 v138, v166 offset:512
    ds_read_b32 v139, v7 offset:512
    ds_read_b128 v[160:163], v165 offset:256
    ds_read_b128 v[164:167], v6 offset:256
    s_waitcnt lgkmcnt(8)
    v_pk_fma_f32 v[20:21], v[140:141], v[130:131], v[20:21] op_sel:[0,1,0] op_sel_hi:[1,1,1]
    v_pk_fma_f32 v[22:23], v[142:143], v[130:131], v[22:23] op_sel:[0,1,0] op_sel_hi:[1,1,1]
    v_pk_fma_f32 v[36:37], v[144:145], v[130:131], v[36:37] op_sel:[0,1,0] op_sel_hi:[1,1,1]
    v_pk_fma_f32 v[38:39], v[146:147], v[130:131], v[38:39] op_sel:[0,1,0] op_sel_hi:[1,1,1]
    v_pk_mul_f32 v[20:21], v[20:21], v[130:131] op_sel_hi:[1,0]
    v_pk_mul_f32 v[22:23], v[22:23], v[130:131] op_sel_hi:[1,0]
    v_pk_mul_f32 v[36:37], v[36:37], v[130:131] op_sel_hi:[1,0]
    v_pk_mul_f32 v[38:39], v[38:39], v[130:131] op_sel_hi:[1,0]
    v_cvt_pk_bf16_f32 v20, v20, v21
    v_cvt_pk_bf16_f32 v21, v22, v23
    v_cvt_pk_bf16_f32 v22, v36, v37
    v_cvt_pk_bf16_f32 v23, v38, v39
    v_pk_fma_f32 v[24:25], v[140:141], v[132:133], v[24:25] op_sel:[0,1,0] op_sel_hi:[1,1,1]
    v_pk_fma_f32 v[26:27], v[142:143], v[132:133], v[26:27] op_sel:[0,1,0] op_sel_hi:[1,1,1]
    v_pk_fma_f32 v[40:41], v[144:145], v[132:133], v[40:41] op_sel:[0,1,0] op_sel_hi:[1,1,1]
    v_pk_fma_f32 v[42:43], v[146:147], v[132:133], v[42:43] op_sel:[0,1,0] op_sel_hi:[1,1,1]
    v_pk_mul_f32 v[24:25], v[24:25], v[132:133] op_sel_hi:[1,0]
    v_pk_mul_f32 v[26:27], v[26:27], v[132:133] op_sel_hi:[1,0]
    v_pk_mul_f32 v[40:41], v[40:41], v[132:133] op_sel_hi:[1,0]
    v_pk_mul_f32 v[42:43], v[42:43], v[132:133] op_sel_hi:[1,0]
    v_cvt_pk_bf16_f32 v24, v24, v25
    v_cvt_pk_bf16_f32 v25, v26, v27
    v_cvt_pk_bf16_f32 v26, v40, v41
    v_cvt_pk_bf16_f32 v27, v42, v43
    v_pk_fma_f32 v[28:29], v[140:141], v[134:135], v[28:29] op_sel:[0,1,0] op_sel_hi:[1,1,1]
    v_pk_fma_f32 v[30:31], v[142:143], v[134:135], v[30:31] op_sel:[0,1,0] op_sel_hi:[1,1,1]
    v_pk_fma_f32 v[44:45], v[144:145], v[134:135], v[44:45] op_sel:[0,1,0] op_sel_hi:[1,1,1]
    v_pk_fma_f32 v[46:47], v[146:147], v[134:135], v[46:47] op_sel:[0,1,0] op_sel_hi:[1,1,1]
    v_pk_mul_f32 v[28:29], v[28:29], v[134:135] op_sel_hi:[1,0]
    v_pk_mul_f32 v[30:31], v[30:31], v[134:135] op_sel_hi:[1,0]
    v_pk_mul_f32 v[44:45], v[44:45], v[134:135] op_sel_hi:[1,0]
    v_pk_mul_f32 v[46:47], v[46:47], v[134:135] op_sel_hi:[1,0]
    v_cvt_pk_bf16_f32 v28, v28, v29
    v_cvt_pk_bf16_f32 v29, v30, v31
    v_cvt_pk_bf16_f32 v30, v44, v45
    v_cvt_pk_bf16_f32 v31, v46, v47
    v_pk_fma_f32 v[32:33], v[140:141], v[136:137], v[32:33] op_sel:[0,1,0] op_sel_hi:[1,1,1]
    v_pk_fma_f32 v[34:35], v[142:143], v[136:137], v[34:35] op_sel:[0,1,0] op_sel_hi:[1,1,1]
    v_pk_fma_f32 v[48:49], v[144:145], v[136:137], v[48:49] op_sel:[0,1,0] op_sel_hi:[1,1,1]
    v_pk_fma_f32 v[50:51], v[146:147], v[136:137], v[50:51] op_sel:[0,1,0] op_sel_hi:[1,1,1]
    v_pk_mul_f32 v[32:33], v[32:33], v[136:137] op_sel_hi:[1,0]
    v_pk_mul_f32 v[34:35], v[34:35], v[136:137] op_sel_hi:[1,0]
    v_pk_mul_f32 v[48:49], v[48:49], v[136:137] op_sel_hi:[1,0]
    v_pk_mul_f32 v[50:51], v[50:51], v[136:137] op_sel_hi:[1,0]
    v_cvt_pk_bf16_f32 v32, v32, v33
    v_cvt_pk_bf16_f32 v33, v34, v35
    v_cvt_pk_bf16_f32 v34, v48, v49
    v_cvt_pk_bf16_f32 v35, v50, v51
    s_waitcnt lgkmcnt(0)
    v_pk_fma_f32 v[56:57], v[160:161], v[130:131], v[56:57] op_sel:[0,1,0] op_sel_hi:[1,1,1]
    v_pk_fma_f32 v[58:59], v[162:163], v[130:131], v[58:59] op_sel:[0,1,0] op_sel_hi:[1,1,1]
    v_pk_fma_f32 v[72:73], v[164:165], v[130:131], v[72:73] op_sel:[0,1,0] op_sel_hi:[1,1,1]
    v_pk_fma_f32 v[74:75], v[166:167], v[130:131], v[74:75] op_sel:[0,1,0] op_sel_hi:[1,1,1]
    v_pk_mul_f32 v[56:57], v[56:57], v[130:131] op_sel_hi:[1,0]
    v_pk_mul_f32 v[58:59], v[58:59], v[130:131] op_sel_hi:[1,0]
    v_pk_mul_f32 v[72:73], v[72:73], v[130:131] op_sel_hi:[1,0]
    v_pk_mul_f32 v[74:75], v[74:75], v[130:131] op_sel_hi:[1,0]
    v_cvt_pk_bf16_f32 v56, v56, v57
    v_cvt_pk_bf16_f32 v57, v58, v59
    v_cvt_pk_bf16_f32 v58, v72, v73
    v_cvt_pk_bf16_f32 v59, v74, v75
    v_pk_fma_f32 v[60:61], v[160:161], v[132:133], v[60:61] op_sel:[0,1,0] op_sel_hi:[1,1,1]
    v_pk_fma_f32 v[62:63], v[162:163], v[132:133], v[62:63] op_sel:[0,1,0] op_sel_hi:[1,1,1]
    v_pk_fma_f32 v[76:77], v[164:165], v[132:133], v[76:77] op_sel:[0,1,0] op_sel_hi:[1,1,1]
    v_pk_fma_f32 v[78:79], v[166:167], v[132:133], v[78:79] op_sel:[0,1,0] op_sel_hi:[1,1,1]
    v_pk_mul_f32 v[60:61], v[60:61], v[132:133] op_sel_hi:[1,0]
    v_pk_mul_f32 v[62:63], v[62:63], v[132:133] op_sel_hi:[1,0]
    v_pk_mul_f32 v[76:77], v[76:77], v[132:133] op_sel_hi:[1,0]
    v_pk_mul_f32 v[78:79], v[78:79], v[132:133] op_sel_hi:[1,0]
    v_cvt_pk_bf16_f32 v60, v60, v61
    v_cvt_pk_bf16_f32 v61, v62, v63
    v_cvt_pk_bf16_f32 v62, v76, v77
    v_cvt_pk_bf16_f32 v63, v78, v79
    v_pk_fma_f32 v[64:65], v[160:161], v[134:135], v[64:65] op_sel:[0,1,0] op_sel_hi:[1,1,1]
    v_pk_fma_f32 v[66:67], v[162:163], v[134:135], v[66:67] op_sel:[0,1,0] op_sel_hi:[1,1,1]
    v_pk_fma_f32 v[80:81], v[164:165], v[134:135], v[80:81] op_sel:[0,1,0] op_sel_hi:[1,1,1]
    v_pk_fma_f32 v[82:83], v[166:167], v[134:135], v[82:83] op_sel:[0,1,0] op_sel_hi:[1,1,1]
    v_pk_mul_f32 v[64:65], v[64:65], v[134:135] op_sel_hi:[1,0]
    v_pk_mul_f32 v[66:67], v[66:67], v[134:135] op_sel_hi:[1,0]
    v_pk_mul_f32 v[80:81], v[80:81], v[134:135] op_sel_hi:[1,0]
    v_pk_mul_f32 v[82:83], v[82:83], v[134:135] op_sel_hi:[1,0]
    v_cvt_pk_bf16_f32 v64, v64, v65
    v_cvt_pk_bf16_f32 v65, v66, v67
    v_cvt_pk_bf16_f32 v66, v80, v81
    v_cvt_pk_bf16_f32 v67, v82, v83
    v_pk_fma_f32 v[68:69], v[160:161], v[136:137], v[68:69] op_sel:[0,1,0] op_sel_hi:[1,1,1]
    v_pk_fma_f32 v[70:71], v[162:163], v[136:137], v[70:71] op_sel:[0,1,0] op_sel_hi:[1,1,1]
    v_pk_fma_f32 v[84:85], v[164:165], v[136:137], v[84:85] op_sel:[0,1,0] op_sel_hi:[1,1,1]
    v_pk_fma_f32 v[86:87], v[166:167], v[136:137], v[86:87] op_sel:[0,1,0] op_sel_hi:[1,1,1]
    v_pk_mul_f32 v[68:69], v[68:69], v[136:137] op_sel_hi:[1,0]
    v_pk_mul_f32 v[70:71], v[70:71], v[136:137] op_sel_hi:[1,0]
    v_pk_mul_f32 v[84:85], v[84:85], v[136:137] op_sel_hi:[1,0]
    v_pk_mul_f32 v[86:87], v[86:87], v[136:137] op_sel_hi:[1,0]
    v_cvt_pk_bf16_f32 v68, v68, v69
    v_cvt_pk_bf16_f32 v69, v70, v71
    v_cvt_pk_bf16_f32 v70, v84, v85
    v_cvt_pk_bf16_f32 v71, v86, v87
    v_pk_fma_f32 v[52:53], v[160:161], v[128:129], v[52:53] op_sel:[0,1,0] op_sel_hi:[1,1,1]
    v_pk_fma_f32 v[54:55], v[162:163], v[128:129], v[54:55] op_sel:[0,1,0] op_sel_hi:[1,1,1]
    v_pk_fma_f32 v[16:17], v[164:165], v[128:129], v[16:17] op_sel:[0,1,0] op_sel_hi:[1,1,1]
    v_pk_fma_f32 v[18:19], v[166:167], v[128:129], v[18:19] op_sel:[0,1,0] op_sel_hi:[1,1,1]
    v_pk_mul_f32 v[52:53], v[52:53], v[128:129] op_sel_hi:[1,0]
    v_pk_mul_f32 v[54:55], v[54:55], v[128:129] op_sel_hi:[1,0]
    v_pk_mul_f32 v[16:17], v[16:17], v[128:129] op_sel_hi:[1,0]
    v_pk_mul_f32 v[18:19], v[18:19], v[128:129] op_sel_hi:[1,0]
    v_cvt_pk_bf16_f32 v52, v52, v53
    v_cvt_pk_bf16_f32 v53, v54, v55
    v_cvt_pk_bf16_f32 v54, v16, v17
    v_cvt_pk_bf16_f32 v55, v18, v19
    v_mfma_f32_16x16x32_bf16 v[76:79], v[60:63], v[24:27], 0
    v_mfma_f32_16x16x32_bf16 v[40:43], v[56:59], v[24:27], 0
    v_mfma_f32_16x16x32_bf16 v[80:83], v[64:67], v[28:31], 0
    v_mfma_f32_16x16x32_bf16 v[44:47], v[60:63], v[28:31], 0
    v_mfma_f32_16x16x32_bf16 v[84:87], v[68:71], v[32:35], 0
    v_mfma_f32_16x16x32_bf16 v[48:51], v[64:67], v[32:35], 0
    v_mfma_f32_16x16x32_bf16 v[72:75], v[56:59], v[20:23], 0
    v_mfma_f32_16x16x32_bf16 v[36:39], v[52:55], v[20:23], 0
    s_mov_b32 s64, 0x3e8293ee
    s_mov_b32 s65, s64
    ds_read_b128 v[140:143], v5 offset:64
    ds_read_b128 v[144:147], v5 offset:640
    s_waitcnt lgkmcnt(2)
    v_pk_fma_f32 v[88:89], v[12:13], v[138:139], v[88:89] op_sel_hi:[1,0,1]
    v_pk_fma_f32 v[90:91], v[14:15], v[138:139], v[90:91] op_sel_hi:[1,0,1]
    v_pk_fma_f32 v[124:125], v[12:13], v[138:139], v[124:125] op_sel:[0,1,0] op_sel_hi:[1,1,1]
    v_pk_fma_f32 v[126:127], v[14:15], v[138:139], v[126:127] op_sel:[0,1,0] op_sel_hi:[1,1,1]
    v_pk_mul_f32 v[88:89], v[88:89], v[8:9]
    v_pk_mul_f32 v[90:91], v[90:91], v[10:11]
    v_pk_mul_f32 v[124:125], v[124:125], v[8:9]
    v_pk_mul_f32 v[126:127], v[126:127], v[10:11]
    ds_read_b128 v[8:11], v5 offset:128
    ds_read_b128 v[12:15], v5 offset:704
    s_waitcnt lgkmcnt(2)
    v_pk_fma_f32 v[92:93], v[144:145], v[138:139], v[92:93] op_sel_hi:[1,0,1]
    v_pk_fma_f32 v[94:95], v[146:147], v[138:139], v[94:95] op_sel_hi:[1,0,1]
    v_pk_fma_f32 v[108:109], v[144:145], v[138:139], v[108:109] op_sel:[0,1,0] op_sel_hi:[1,1,1]
    v_pk_fma_f32 v[110:111], v[146:147], v[138:139], v[110:111] op_sel:[0,1,0] op_sel_hi:[1,1,1]
    v_pk_mul_f32 v[92:93], v[92:93], v[140:141]
    v_pk_mul_f32 v[94:95], v[94:95], v[142:143]
    v_pk_mul_f32 v[108:109], v[108:109], v[140:141]
    v_pk_mul_f32 v[110:111], v[110:111], v[142:143]
    v_cvt_pk_bf16_f32 v130, v92, v93
    v_cvt_pk_bf16_f32 v131, v94, v95
    v_cvt_pk_bf16_f32 v160, v108, v109
    v_cvt_pk_bf16_f32 v161, v110, v111
    ds_read_b128 v[140:143], v5 offset:192
    ds_read_b128 v[144:147], v5 offset:768
    s_waitcnt lgkmcnt(2)
    v_pk_fma_f32 v[96:97], v[12:13], v[138:139], v[96:97] op_sel_hi:[1,0,1]
    v_pk_fma_f32 v[98:99], v[14:15], v[138:139], v[98:99] op_sel_hi:[1,0,1]
    v_pk_fma_f32 v[112:113], v[12:13], v[138:139], v[112:113] op_sel:[0,1,0] op_sel_hi:[1,1,1]
    v_pk_fma_f32 v[114:115], v[14:15], v[138:139], v[114:115] op_sel:[0,1,0] op_sel_hi:[1,1,1]
    v_pk_mul_f32 v[96:97], v[96:97], v[8:9]
    v_pk_mul_f32 v[98:99], v[98:99], v[10:11]
    v_pk_mul_f32 v[112:113], v[112:113], v[8:9]
    v_pk_mul_f32 v[114:115], v[114:115], v[10:11]
    v_cvt_pk_bf16_f32 v132, v96, v97
    v_cvt_pk_bf16_f32 v133, v98, v99
    v_cvt_pk_bf16_f32 v162, v112, v113
    v_cvt_pk_bf16_f32 v163, v114, v115
    ds_read_b128 v[8:11], v5 offset:256
    ds_read_b128 v[12:15], v5 offset:832
    s_waitcnt lgkmcnt(2)
    v_pk_fma_f32 v[100:101], v[144:145], v[138:139], v[100:101] op_sel_hi:[1,0,1]
    v_pk_fma_f32 v[102:103], v[146:147], v[138:139], v[102:103] op_sel_hi:[1,0,1]
    v_pk_fma_f32 v[116:117], v[144:145], v[138:139], v[116:117] op_sel:[0,1,0] op_sel_hi:[1,1,1]
    v_pk_fma_f32 v[118:119], v[146:147], v[138:139], v[118:119] op_sel:[0,1,0] op_sel_hi:[1,1,1]
    v_pk_mul_f32 v[100:101], v[100:101], v[140:141]
    v_pk_mul_f32 v[102:103], v[102:103], v[142:143]
    v_pk_mul_f32 v[116:117], v[116:117], v[140:141]
    v_pk_mul_f32 v[118:119], v[118:119], v[142:143]
    v_cvt_pk_bf16_f32 v134, v100, v101
    v_cvt_pk_bf16_f32 v135, v102, v103
    v_cvt_pk_bf16_f32 v164, v116, v117
    v_cvt_pk_bf16_f32 v165, v118, v119
    s_waitcnt lgkmcnt(0)
    v_pk_fma_f32 v[104:105], v[12:13], v[138:139], v[104:105] op_sel_hi:[1,0,1]
    v_pk_fma_f32 v[106:107], v[14:15], v[138:139], v[106:107] op_sel_hi:[1,0,1]
    v_pk_fma_f32 v[120:121], v[12:13], v[138:139], v[120:121] op_sel:[0,1,0] op_sel_hi:[1,1,1]
    v_pk_fma_f32 v[122:123], v[14:15], v[138:139], v[122:123] op_sel:[0,1,0] op_sel_hi:[1,1,1]
    v_pk_mul_f32 v[104:105], v[104:105], v[8:9]
    v_pk_mul_f32 v[106:107], v[106:107], v[10:11]
    v_pk_mul_f32 v[120:121], v[120:121], v[8:9]
    v_pk_mul_f32 v[122:123], v[122:123], v[10:11]
    v_cvt_pk_bf16_f32 v136, v104, v105
    v_cvt_pk_bf16_f32 v137, v106, v107
    v_cvt_pk_bf16_f32 v166, v120, v121
    v_cvt_pk_bf16_f32 v167, v122, v123
    v_pk_fma_f32 v[36:37], v[36:37], s[64:65], v[156:157]
    v_pk_fma_f32 v[38:39], v[38:39], s[64:65], v[158:159]
    v_pk_fma_f32 v[72:73], v[72:73], s[64:65], v[152:153]
    v_pk_fma_f32 v[74:75], v[74:75], s[64:65], v[154:155]
    v_pk_fma_f32 v[40:41], v[40:41], s[64:65], v[148:149]
    v_pk_fma_f32 v[42:43], v[42:43], s[64:65], v[150:151]
    v_pk_fma_f32 v[76:77], v[76:77], s[64:65], v[152:153]
    v_pk_fma_f32 v[78:79], v[78:79], s[64:65], v[154:155]
    v_pk_fma_f32 v[44:45], v[44:45], s[64:65], v[148:149]
    v_pk_fma_f32 v[46:47], v[46:47], s[64:65], v[150:151]
    v_pk_fma_f32 v[80:81], v[80:81], s[64:65], v[152:153]
    v_pk_fma_f32 v[82:83], v[82:83], s[64:65], v[154:155]
    v_pk_fma_f32 v[48:49], v[48:49], s[64:65], v[148:149]
    v_pk_fma_f32 v[50:51], v[50:51], s[64:65], v[150:151]
    v_pk_fma_f32 v[84:85], v[84:85], s[64:65], v[152:153]
    v_pk_fma_f32 v[86:87], v[86:87], s[64:65], v[154:155]
    v_cvt_pk_bf16_f32 v128, v88, v89
    v_cvt_pk_bf16_f32 v129, v90, v91
    v_cvt_pk_bf16_f32 v158, v124, v125
    v_cvt_pk_bf16_f32 v159, v126, v127
    v_max3_f32 v8, v36, v37, v38
    v_max3_f32 v9, v40, v41, v42
    v_max3_f32 v10, v44, v45, v46
    v_max3_f32 v11, v48, v49, v50
    v_max3_f32 v8, v8, v39, v72
    v_max3_f32 v9, v9, v43, v76
    v_max3_f32 v10, v10, v47, v80
    v_max3_f32 v11, v11, v51, v84
    v_max3_f32 v8, v8, v73, v74
    v_max3_f32 v9, v9, v77, v78
    v_max3_f32 v10, v10, v81, v82
    v_max3_f32 v11, v11, v85, v86
    v_max_f32 v8, v8, v75
    v_max_f32 v9, v9, v79
    v_max_f32 v10, v10, v83
    v_max_f32 v11, v11, v87
    v_mov_b32 v12, v8
    v_mov_b32 v13, v9
    v_mov_b32 v14, v10
    v_mov_b32 v15, v11
    v_permlane16_swap_b32 v8, v12
    v_permlane16_swap_b32 v9, v13
    v_permlane16_swap_b32 v10, v14
    v_permlane16_swap_b32 v11, v15
    v_max_f32 v8, v8, v12
    v_max_f32 v9, v9, v13
    v_max_f32 v10, v10, v14
    v_max_f32 v11, v11, v15
    v_mov_b32 v12, v8
    v_mov_b32 v13, v9
    v_mov_b32 v14, v10
    v_mov_b32 v15, v11
    v_permlane32_swap_b32 v8, v12
    v_permlane32_swap_b32 v9, v13
    v_permlane32_swap_b32 v10, v14
    v_permlane32_swap_b32 v11, v15
    v_max_f32 v8, v8, v12
    v_max_f32 v9, v9, v13
    v_max_f32 v10, v10, v14
    v_max_f32 v11, v11, v15
    v_pk_add_f32 v[36:37], v[36:37], v[8:9] op_sel_hi:[1,0] neg_lo:[0,1] neg_hi:[0,1]
    v_pk_add_f32 v[38:39], v[38:39], v[8:9] op_sel_hi:[1,0] neg_lo:[0,1] neg_hi:[0,1]
    v_pk_add_f32 v[72:73], v[72:73], v[8:9] op_sel_hi:[1,0] neg_lo:[0,1] neg_hi:[0,1]
    v_pk_add_f32 v[74:75], v[74:75], v[8:9] op_sel_hi:[1,0] neg_lo:[0,1] neg_hi:[0,1]
    v_pk_add_f32 v[40:41], v[40:41], v[8:9] op_sel:[0,1] op_sel_hi:[1,1] neg_lo:[0,1] neg_hi:[0,1]
    v_pk_add_f32 v[42:43], v[42:43], v[8:9] op_sel:[0,1] op_sel_hi:[1,1] neg_lo:[0,1] neg_hi:[0,1]
    v_pk_add_f32 v[76:77], v[76:77], v[8:9] op_sel:[0,1] op_sel_hi:[1,1] neg_lo:[0,1] neg_hi:[0,1]
    v_pk_add_f32 v[78:79], v[78:79], v[8:9] op_sel:[0,1] op_sel_hi:[1,1] neg_lo:[0,1] neg_hi:[0,1]
    v_pk_add_f32 v[44:45], v[44:45], v[10:11] op_sel_hi:[1,0] neg_lo:[0,1] neg_hi:[0,1]
    v_pk_add_f32 v[46:47], v[46:47], v[10:11] op_sel_hi:[1,0] neg_lo:[0,1] neg_hi:[0,1]
    v_pk_add_f32 v[80:81], v[80:81], v[10:11] op_sel_hi:[1,0] neg_lo:[0,1] neg_hi:[0,1]
    v_pk_add_f32 v[82:83], v[82:83], v[10:11] op_sel_hi:[1,0] neg_lo:[0,1] neg_hi:[0,1]
    v_pk_add_f32 v[48:49], v[48:49], v[10:11] op_sel:[0,1] op_sel_hi:[1,1] neg_lo:[0,1] neg_hi:[0,1]
    v_pk_add_f32 v[50:51], v[50:51], v[10:11] op_sel:[0,1] op_sel_hi:[1,1] neg_lo:[0,1] neg_hi:[0,1]
    v_pk_add_f32 v[84:85], v[84:85], v[10:11] op_sel:[0,1] op_sel_hi:[1,1] neg_lo:[0,1] neg_hi:[0,1]
    v_pk_add_f32 v[86:87], v[86:87], v[10:11] op_sel:[0,1] op_sel_hi:[1,1] neg_lo:[0,1] neg_hi:[0,1]
    v_exp_f32 v36, v36
    v_exp_f32 v37, v37
    v_exp_f32 v38, v38
    v_exp_f32 v39, v39
    v_exp_f32 v72, v72
    v_exp_f32 v73, v73
    v_exp_f32 v74, v74
    v_exp_f32 v75, v75
    v_exp_f32 v40, v40
    v_exp_f32 v41, v41
    v_exp_f32 v42, v42
    v_exp_f32 v43, v43
    v_exp_f32 v76, v76
    v_exp_f32 v77, v77
    v_exp_f32 v78, v78
    v_exp_f32 v79, v79
    v_exp_f32 v44, v44
    v_exp_f32 v45, v45
    v_exp_f32 v46, v46
    v_exp_f32 v47, v47
    v_exp_f32 v80, v80
    v_exp_f32 v81, v81
    v_exp_f32 v82, v82
    v_exp_f32 v83, v83
    v_exp_f32 v48, v48
    v_exp_f32 v49, v49
    v_exp_f32 v50, v50
    v_exp_f32 v51, v51
    v_exp_f32 v84, v84
    v_exp_f32 v85, v85
    v_exp_f32 v86, v86
    v_exp_f32 v87, v87
    v_pk_add_f32 v[140:141], v[36:37], v[38:39]
    v_pk_add_f32 v[144:145], v[40:41], v[42:43]
    v_pk_add_f32 v[148:149], v[44:45], v[46:47]
    v_pk_add_f32 v[152:153], v[48:49], v[50:51]
    v_pk_add_f32 v[142:143], v[72:73], v[74:75]
    v_pk_add_f32 v[146:147], v[76:77], v[78:79]
    v_pk_add_f32 v[150:151], v[80:81], v[82:83]
    v_pk_add_f32 v[154:155], v[84:85], v[86:87]
    v_pk_add_f32 v[140:141], v[140:141], v[142:143]
    v_pk_add_f32 v[144:145], v[144:145], v[146:147]
    v_pk_add_f32 v[148:149], v[148:149], v[150:151]
    v_pk_add_f32 v[152:153], v[152:153], v[154:155]
    v_add_f32 v8, v140, v141
    v_add_f32 v9, v144, v145
    v_add_f32 v10, v148, v149
    v_add_f32 v11, v152, v153
    v_mov_b32 v12, v8
    v_mov_b32 v13, v9
    v_mov_b32 v14, v10
    v_mov_b32 v15, v11
    v_permlane16_swap_b32 v8, v12
    v_permlane16_swap_b32 v9, v13
    v_permlane16_swap_b32 v10, v14
    v_permlane16_swap_b32 v11, v15
    v_add_f32 v8, v8, v12
    v_add_f32 v9, v9, v13
    v_add_f32 v10, v10, v14
    v_add_f32 v11, v11, v15
    v_mov_b32 v12, v8
    v_mov_b32 v13, v9
    v_mov_b32 v14, v10
    v_mov_b32 v15, v11
    v_permlane32_swap_b32 v8, v12
    v_permlane32_swap_b32 v9, v13
    v_permlane32_swap_b32 v10, v14
    v_permlane32_swap_b32 v11, v15
    v_add_f32 v8, v8, v12
    v_add_f32 v9, v9, v13
    v_add_f32 v10, v10, v14
    v_add_f32 v11, v11, v15
    v_rcp_f32 v8, v8
    v_rcp_f32 v9, v9
    v_rcp_f32 v10, v10
    v_rcp_f32 v11, v11
    s_lshl_b32 s34, s25, 5
    s_lshl_b32 s35, s26, 1
    v_pk_mul_f32 v[36:37], v[36:37], v[8:9] op_sel_hi:[1,0]
    v_pk_mul_f32 v[38:39], v[38:39], v[8:9] op_sel_hi:[1,0]
    v_pk_mul_f32 v[72:73], v[72:73], v[8:9] op_sel_hi:[1,0]
    v_pk_mul_f32 v[74:75], v[74:75], v[8:9] op_sel_hi:[1,0]
    v_cvt_pk_bf16_f32 v20, v36, v37
    v_cvt_pk_bf16_f32 v21, v38, v39
    v_cvt_pk_bf16_f32 v22, v72, v73
    v_cvt_pk_bf16_f32 v23, v74, v75
    v_pk_mul_f32 v[40:41], v[40:41], v[8:9] op_sel:[0,1] op_sel_hi:[1,1]
    v_pk_mul_f32 v[42:43], v[42:43], v[8:9] op_sel:[0,1] op_sel_hi:[1,1]
    v_pk_mul_f32 v[76:77], v[76:77], v[8:9] op_sel:[0,1] op_sel_hi:[1,1]
    v_pk_mul_f32 v[78:79], v[78:79], v[8:9] op_sel:[0,1] op_sel_hi:[1,1]
    v_cvt_pk_bf16_f32 v24, v40, v41
    v_cvt_pk_bf16_f32 v25, v42, v43
    v_cvt_pk_bf16_f32 v26, v76, v77
    v_cvt_pk_bf16_f32 v27, v78, v79
    v_pk_mul_f32 v[44:45], v[44:45], v[10:11] op_sel_hi:[1,0]
    v_pk_mul_f32 v[46:47], v[46:47], v[10:11] op_sel_hi:[1,0]
    v_pk_mul_f32 v[80:81], v[80:81], v[10:11] op_sel_hi:[1,0]
    v_pk_mul_f32 v[82:83], v[82:83], v[10:11] op_sel_hi:[1,0]
    v_cvt_pk_bf16_f32 v28, v44, v45
    v_cvt_pk_bf16_f32 v29, v46, v47
    v_cvt_pk_bf16_f32 v30, v80, v81
    v_cvt_pk_bf16_f32 v31, v82, v83
    v_pk_mul_f32 v[48:49], v[48:49], v[10:11] op_sel:[0,1] op_sel_hi:[1,1]
    v_pk_mul_f32 v[50:51], v[50:51], v[10:11] op_sel:[0,1] op_sel_hi:[1,1]
    v_pk_mul_f32 v[84:85], v[84:85], v[10:11] op_sel:[0,1] op_sel_hi:[1,1]
    v_pk_mul_f32 v[86:87], v[86:87], v[10:11] op_sel:[0,1] op_sel_hi:[1,1]
    v_cvt_pk_bf16_f32 v32, v48, v49
    v_cvt_pk_bf16_f32 v33, v50, v51
    v_cvt_pk_bf16_f32 v34, v84, v85
    v_cvt_pk_bf16_f32 v35, v86, v87
    s_add_u32 s34, s34, s35
    s_add_u32 s34, s34, s28
    v_mfma_f32_16x16x32_bf16 v[36:39], v[128:131], v[20:23], 0
    v_mfma_f32_16x16x32_bf16 v[72:75], v[158:161], v[20:23], 0
    v_mfma_f32_16x16x32_bf16 v[40:43], v[130:133], v[24:27], 0
    v_mfma_f32_16x16x32_bf16 v[76:79], v[160:163], v[24:27], 0
    v_mfma_f32_16x16x32_bf16 v[44:47], v[132:135], v[28:31], 0
    v_mfma_f32_16x16x32_bf16 v[80:83], v[162:165], v[28:31], 0
    v_mfma_f32_16x16x32_bf16 v[48:51], v[134:137], v[32:35], 0
    v_mfma_f32_16x16x32_bf16 v[84:87], v[164:167], v[32:35], 0
    s_lshl_b32 s34, s34, 1
    s_add_u32 s34, s34, s27
    s_lshl_b32 s34, s34, 12
    s_lshl_b32 s35, s27, 1
    v_xor_b32 v3, s35, v3
    v_lshlrev_b32 v4, 6, v2
    v_lshl_add_u32 v4, v3, 4, v4
    v_cvt_pk_bf16_f32 v56, v36, v37
    v_cvt_pk_bf16_f32 v57, v38, v39
    v_cvt_pk_bf16_f32 v58, v72, v73
    v_cvt_pk_bf16_f32 v59, v74, v75
    v_cvt_pk_bf16_f32 v60, v40, v41
    v_cvt_pk_bf16_f32 v61, v42, v43
    v_cvt_pk_bf16_f32 v62, v76, v77
    v_cvt_pk_bf16_f32 v63, v78, v79
    v_cvt_pk_bf16_f32 v64, v44, v45
    v_cvt_pk_bf16_f32 v65, v46, v47
    v_cvt_pk_bf16_f32 v66, v80, v81
    v_cvt_pk_bf16_f32 v67, v82, v83
    v_cvt_pk_bf16_f32 v68, v48, v49
    v_cvt_pk_bf16_f32 v69, v50, v51
    v_cvt_pk_bf16_f32 v70, v84, v85
    v_cvt_pk_bf16_f32 v71, v86, v87
    v_permlane32_swap_b32 v56, v58
    v_permlane32_swap_b32 v57, v59
    s_nop 0
    v_permlane16_swap_b32 v56, v58
    v_permlane16_swap_b32 v57, v59
    buffer_store_dwordx4 v[56:59], v4, s[12:15], s34 offen offset:0 sc1
    v_permlane32_swap_b32 v60, v62
    v_permlane32_swap_b32 v61, v63
    s_nop 0
    v_permlane16_swap_b32 v60, v62
    v_permlane16_swap_b32 v61, v63
    buffer_store_dwordx4 v[60:63], v4, s[12:15], s34 offen offset:1024 sc1
    v_permlane32_swap_b32 v64, v66
    v_permlane32_swap_b32 v65, v67
    s_nop 0
    v_permlane16_swap_b32 v64, v66
    v_permlane16_swap_b32 v65, v67
    buffer_store_dwordx4 v[64:67], v4, s[12:15], s34 offen offset:2048 sc1
    v_permlane32_swap_b32 v68, v70
    v_permlane32_swap_b32 v69, v71
    s_nop 0
    v_permlane16_swap_b32 v68, v70
    v_permlane16_swap_b32 v69, v71
    buffer_store_dwordx4 v[68:71], v4, s[12:15], s34 offen offset:3072 sc1
p2_c:
    s_and_b32 s34, s2, 7
    s_lshr_b32 s35, s2, 3
    s_lshr_b32 s39, s35, 3
    s_and_b32 s54, s35, 7
    s_lshr_b32 s36, s34, 1
    s_and_b32 s37, s34, 1
    s_lshl_b32 s25, s36, 2
    s_lshl_b32 s26, s37, 3
    s_add_u32 s25, s25, s39
    s_add_u32 s26, s26, s54
    s_lshr_b32 s27, s24, 0
    s_and_b32 s28, s24, 0
    v_and_b32 v16, 15, v1
    v_lshrrev_b32 v17, 4, v1
    v_bfe_u32 v18, v16, 1, 3
    v_xor_b32 v18, v18, v17
    v_lshlrev_b32 v18, 4, v18
    v_lshl_add_u32 v19, v16, 7, v18
    s_mul_i32 s34, s27, 4096
    s_add_u32 s34, s34, 98304
    v_add_u32 v2, s34, v19
    v_xor_b32 v3, 64, v2
    v_bfe_u32 v18, v1, 2, 2
    v_lshl_add_u32 v18, v17, 3, v18
    v_bfe_u32 v19, v1, 1, 1
    v_and_b32 v20, 1, v1
    v_lshlrev_b32 v20, 3, v20
    v_bfe_u32 v21, v1, 3, 2
    v_lshlrev_b32 v21, 1, v21
    v_xor_b32 v21, v21, v19
    v_lshl_add_u32 v21, v21, 4, v20
    v_lshl_add_u32 v21, v18, 7, v21
    v_xor_b32 v4, 0, v21
    v_add_u32 v4, 0, v4
    v_xor_b32 v5, 32, v21
    v_add_u32 v5, 0, v5
    v_xor_b32 v6, 64, v21
    v_add_u32 v6, 0, v6
    v_xor_b32 v7, 96, v21
    v_add_u32 v7, 0, v7
    s_add_u32 s12, s92, 0x800000
    s_addc_u32 s13, s93, 0
    s_mov_b32 s14, 0x400000
    s_mov_b32 s15, 0x20000
    s_add_u32 s20, s92, 0x1c00000
    s_addc_u32 s21, s93, 0
    s_mov_b32 s22, 0x40000
    s_mov_b32 s23, 0x20000
    v_and_b32 v80, 15, v1
    v_lshrrev_b32 v81, 4, v1
    s_lshl_b32 s34, s25, 4
    s_add_u32 s34, s34, s26
    s_lshl_b32 s34, s34, 14
    s_lshl_b32 s35, s27, 11
    s_add_u32 s64, s34, s35
    s_add_u32 s65, s64, 8192
    v_lshlrev_b32 v82, 6, v80
    v_lshl_add_u32 v84, v81, 4, v82
    v_bfe_u32 v82, v80, 1, 3
    v_lshrrev_b32 v83, 1, v81
    v_xor_b32 v82, v82, v83
    v_lshlrev_b32 v82, 4, v82
    v_and_b32 v83, 1, v81
    v_lshl_add_u32 v82, v83, 3, v82
    v_lshl_add_u32 v82, v80, 7, v82
    s_lshl_b32 s34, s24, 12
    s_add_u32 s34, s34, 45056
    v_xor_b32 v48, 0, v82
    v_add_u32 v48, s34, v48
    v_xor_b32 v49, 32, v82
    v_add_u32 v49, s34, v49
    v_xor_b32 v50, 64, v82
    v_add_u32 v50, s34, v50
    v_xor_b32 v51, 96, v82
    v_add_u32 v51, s34, v51
    v_and_b32 v113, 31, v1
    v_lshlrev_b32 v113, 3, v113
    v_lshrrev_b32 v114, 5, v1
    v_lshl_add_u32 v116, v114, 2, v113
    s_lshl_b32 s34, s26, 14
    s_lshl_b32 s35, s25, 10
    s_add_u32 s34, s34, s35
    s_lshl_b32 s35, s27, 8
    s_add_u32 s68, s34, s35
    v_mov_b64 v[16:17], 0
    v_mov_b64 v[18:19], 0
    v_mov_b64 v[20:21], 0
    v_mov_b64 v[22:23], 0
    v_mov_b64 v[24:25], 0
    v_mov_b64 v[26:27], 0
    v_mov_b64 v[28:29], 0
    v_mov_b64 v[30:31], 0
    v_mov_b64 v[32:33], 0
    v_mov_b64 v[34:35], 0
    v_mov_b64 v[36:37], 0
    v_mov_b64 v[38:39], 0
    v_mov_b64 v[40:41], 0
    v_mov_b64 v[42:43], 0
    v_mov_b64 v[44:45], 0
    v_mov_b64 v[46:47], 0
    s_mov_b32 s32, 0
    s_mov_b32 s36, 16384
    s_mov_b32 s37, 4294918144
    s_setprio 3
    s_waitcnt vmcnt(0)
    s_barrier
    s_barrier
    s_barrier
    s_mov_b32 s40, 0
    s_mov_b32 s41, 8192
    s_mov_b32 s42, 4294877184
    ds_read_b128 a[0:3], v2 offset:0
    ds_read_b128 a[4:7], v2 offset:2048
    ds_read_b64_tr_b16 a[8:9], v4 offset:0
    ds_read_b64_tr_b16 a[10:11], v4 offset:512
    ds_read_b64_tr_b16 a[12:13], v5 offset:0
    ds_read_b64_tr_b16 a[14:15], v5 offset:512
    ds_read_b64_tr_b16 a[16:17], v6 offset:0
    ds_read_b64_tr_b16 a[18:19], v6 offset:512
    ds_read_b64_tr_b16 a[20:21], v7 offset:0
    ds_read_b64_tr_b16 a[22:23], v7 offset:512
    ds_read_b128 a[24:27], v3 offset:0
    ds_read_b128 a[28:31], v3 offset:2048
    ds_read_b64_tr_b16 a[32:33], v4 offset:4096
    ds_read_b64_tr_b16 a[34:35], v4 offset:4608
    ds_read_b64_tr_b16 a[36:37], v5 offset:4096
    ds_read_b64_tr_b16 a[38:39], v5 offset:4608
    ds_read_b64_tr_b16 a[40:41], v6 offset:4096
    ds_read_b64_tr_b16 a[42:43], v6 offset:4608
    ds_read_b64_tr_b16 a[44:45], v7 offset:4096
    ds_read_b64_tr_b16 a[46:47], v7 offset:4608
    s_add_u32 s32, s32, 16384
    s_cmp_eq_u32 s32, 65536
    s_cselect_b32 s33, s37, s36
    s_cselect_b32 s32, 0, s32
    v_add_u32 v2, s33, v2
    v_add_u32 v3, s33, v3
    s_add_u32 s40, s40, 8192
    s_cmp_eq_u32 s40, 98304
    s_cselect_b32 s43, s42, s41
    s_cselect_b32 s40, 0, s40
    v_add_u32 v4, s43, v4
    v_add_u32 v5, s43, v5
    v_add_u32 v6, s43, v6
    v_add_u32 v7, s43, v7
    s_mov_b32 s31, 8
Lc_7:
    s_waitcnt lgkmcnt(0)
    s_barrier
    v_mfma_f32_16x16x32_bf16 v[16:19], a[8:11], a[0:3], v[16:19]
    ds_read_b128 a[48:51], v2 offset:0
    ds_read_b128 a[52:55], v2 offset:2048
    v_mfma_f32_16x16x32_bf16 v[20:23], a[8:11], a[4:7], v[20:23]
    ds_read_b64_tr_b16 a[56:57], v4 offset:0
    ds_read_b64_tr_b16 a[58:59], v4 offset:512
    v_mfma_f32_16x16x32_bf16 v[24:27], a[12:15], a[0:3], v[24:27]
    ds_read_b64_tr_b16 a[60:61], v5 offset:0
    ds_read_b64_tr_b16 a[62:63], v5 offset:512
    v_mfma_f32_16x16x32_bf16 v[28:31], a[12:15], a[4:7], v[28:31]
    ds_read_b64_tr_b16 a[64:65], v6 offset:0
    ds_read_b64_tr_b16 a[66:67], v6 offset:512
    v_mfma_f32_16x16x32_bf16 v[32:35], a[16:19], a[0:3], v[32:35]
    ds_read_b64_tr_b16 a[68:69], v7 offset:0
    ds_read_b64_tr_b16 a[70:71], v7 offset:512
    v_mfma_f32_16x16x32_bf16 v[36:39], a[16:19], a[4:7], v[36:39]
    ds_read_b128 a[72:75], v3 offset:0
    ds_read_b128 a[76:79], v3 offset:2048
    v_mfma_f32_16x16x32_bf16 v[40:43], a[20:23], a[0:3], v[40:43]
    ds_read_b64_tr_b16 a[80:81], v4 offset:4096
    ds_read_b64_tr_b16 a[82:83], v4 offset:4608
    v_mfma_f32_16x16x32_bf16 v[44:47], a[20:23], a[4:7], v[44:47]
    ds_read_b64_tr_b16 a[84:85], v5 offset:4096
    ds_read_b64_tr_b16 a[86:87], v5 offset:4608
    v_mfma_f32_16x16x32_bf16 v[16:19], a[32:35], a[24:27], v[16:19]
    ds_read_b64_tr_b16 v[140:141], v6 offset:4096
    ds_read_b64_tr_b16 v[142:143], v6 offset:4608
    v_mfma_f32_16x16x32_bf16 v[20:23], a[32:35], a[28:31], v[20:23]
    ds_read_b64_tr_b16 v[144:145], v7 offset:4096
    ds_read_b64_tr_b16 v[146:147], v7 offset:4608
    v_mfma_f32_16x16x32_bf16 v[24:27], a[36:39], a[24:27], v[24:27]
    s_add_u32 s32, s32, 16384
    s_cmp_eq_u32 s32, 65536
    v_mfma_f32_16x16x32_bf16 v[28:31], a[36:39], a[28:31], v[28:31]
    s_cselect_b32 s33, s37, s36
    s_cselect_b32 s32, 0, s32
    v_mfma_f32_16x16x32_bf16 v[32:35], a[40:43], a[24:27], v[32:35]
    v_add_u32 v2, s33, v2
    v_add_u32 v3, s33, v3
    v_mfma_f32_16x16x32_bf16 v[36:39], a[40:43], a[28:31], v[36:39]
    s_add_u32 s40, s40, 8192
    s_cmp_eq_u32 s40, 98304
    v_mfma_f32_16x16x32_bf16 v[40:43], a[44:47], a[24:27], v[40:43]
    s_cselect_b32 s43, s42, s41
    s_cselect_b32 s40, 0, s40
    v_mfma_f32_16x16x32_bf16 v[44:47], a[44:47], a[28:31], v[44:47]
    v_add_u32 v4, s43, v4
    v_add_u32 v5, s43, v5
    v_add_u32 v6, s43, v6
    v_add_u32 v7, s43, v7
    s_waitcnt lgkmcnt(0)
    s_barrier
    v_mfma_f32_16x16x32_bf16 v[16:19], a[56:59], a[48:51], v[16:19]
    ds_read_b128 a[0:3], v2 offset:0
    ds_read_b128 a[4:7], v2 offset:2048
    v_mfma_f32_16x16x32_bf16 v[20:23], a[56:59], a[52:55], v[20:23]
    ds_read_b64_tr_b16 a[8:9], v4 offset:0
    ds_read_b64_tr_b16 a[10:11], v4 offset:512
    v_mfma_f32_16x16x32_bf16 v[24:27], a[60:63], a[48:51], v[24:27]
    ds_read_b64_tr_b16 a[12:13], v5 offset:0
    ds_read_b64_tr_b16 a[14:15], v5 offset:512
    v_mfma_f32_16x16x32_bf16 v[28:31], a[60:63], a[52:55], v[28:31]
    ds_read_b64_tr_b16 a[16:17], v6 offset:0
    ds_read_b64_tr_b16 a[18:19], v6 offset:512
    v_mfma_f32_16x16x32_bf16 v[32:35], a[64:67], a[48:51], v[32:35]
    ds_read_b64_tr_b16 a[20:21], v7 offset:0
    ds_read_b64_tr_b16 a[22:23], v7 offset:512
    v_mfma_f32_16x16x32_bf16 v[36:39], a[64:67], a[52:55], v[36:39]
    ds_read_b128 a[24:27], v3 offset:0
    ds_read_b128 a[28:31], v3 offset:2048
    v_mfma_f32_16x16x32_bf16 v[40:43], a[68:71], a[48:51], v[40:43]
    ds_read_b64_tr_b16 a[32:33], v4 offset:4096
    ds_read_b64_tr_b16 a[34:35], v4 offset:4608
    v_mfma_f32_16x16x32_bf16 v[44:47], a[68:71], a[52:55], v[44:47]
    ds_read_b64_tr_b16 a[36:37], v5 offset:4096
    ds_read_b64_tr_b16 a[38:39], v5 offset:4608
    v_mfma_f32_16x16x32_bf16 v[16:19], a[80:83], a[72:75], v[16:19]
    ds_read_b64_tr_b16 a[40:41], v6 offset:4096
    ds_read_b64_tr_b16 a[42:43], v6 offset:4608
    v_mfma_f32_16x16x32_bf16 v[20:23], a[80:83], a[76:79], v[20:23]
    ds_read_b64_tr_b16 a[44:45], v7 offset:4096
    ds_read_b64_tr_b16 a[46:47], v7 offset:4608
    v_mfma_f32_16x16x32_bf16 v[24:27], a[84:87], a[72:75], v[24:27]
    s_add_u32 s32, s32, 16384
    s_cmp_eq_u32 s32, 65536
    v_mfma_f32_16x16x32_bf16 v[28:31], a[84:87], a[76:79], v[28:31]
    s_cselect_b32 s33, s37, s36
    s_cselect_b32 s32, 0, s32
    v_mfma_f32_16x16x32_bf16 v[32:35], v[140:143], a[72:75], v[32:35]
    v_add_u32 v2, s33, v2
    v_add_u32 v3, s33, v3
    v_mfma_f32_16x16x32_bf16 v[36:39], v[140:143], a[76:79], v[36:39]
    s_add_u32 s40, s40, 8192
    s_cmp_eq_u32 s40, 98304
    v_mfma_f32_16x16x32_bf16 v[40:43], v[144:147], a[72:75], v[40:43]
    s_cselect_b32 s43, s42, s41
    s_cselect_b32 s40, 0, s40
    v_mfma_f32_16x16x32_bf16 v[44:47], v[144:147], a[76:79], v[44:47]
    v_add_u32 v4, s43, v4
    v_add_u32 v5, s43, v5
    v_add_u32 v6, s43, v6
    v_add_u32 v7, s43, v7
    s_sub_u32 s31, s31, 1
    s_cmp_lg_u32 s31, 0
    s_cbranch_scc1 Lc_7
    s_waitcnt lgkmcnt(0)
    s_setprio 0
    s_barrier
    s_nop 7
p2_epi:
    ds_read_b64 v[64:65], v48 offset:0
    ds_read_b64 v[66:67], v49 offset:0
    ds_read_b64 v[68:69], v50 offset:0
    ds_read_b64 v[70:71], v51 offset:0
    ds_read_b64 v[72:73], v48 offset:2048
    ds_read_b64 v[74:75], v49 offset:2048
    ds_read_b64 v[76:77], v50 offset:2048
    ds_read_b64 v[78:79], v51 offset:2048
    s_mov_b32 s34, 0x3f803f80
    v_mov_b32 v112, 0
    v_mov_b32 v113, 0
    v_mov_b32 v114, 0
    v_mov_b32 v115, 0
    s_waitcnt lgkmcnt(4)
    v_lshlrev_b32 v86, 16, v64
    v_and_b32 v87, 0xffff0000, v64
    v_lshlrev_b32 v88, 16, v65
    v_and_b32 v89, 0xffff0000, v65
    v_pk_add_f32 v[16:17], v[16:17], v[86:87]
    v_pk_add_f32 v[18:19], v[18:19], v[88:89]
    v_lshlrev_b32 v90, 16, v66
    v_and_b32 v91, 0xffff0000, v66
    v_lshlrev_b32 v92, 16, v67
    v_and_b32 v93, 0xffff0000, v67
    v_pk_add_f32 v[24:25], v[24:25], v[90:91]
    v_pk_add_f32 v[26:27], v[26:27], v[92:93]
    v_lshlrev_b32 v86, 16, v68
    v_and_b32 v87, 0xffff0000, v68
    v_lshlrev_b32 v88, 16, v69
    v_and_b32 v89, 0xffff0000, v69
    v_pk_add_f32 v[32:33], v[32:33], v[86:87]
    v_pk_add_f32 v[34:35], v[34:35], v[88:89]
    v_lshlrev_b32 v90, 16, v70
    v_and_b32 v91, 0xffff0000, v70
    v_lshlrev_b32 v92, 16, v71
    v_and_b32 v93, 0xffff0000, v71
    v_pk_add_f32 v[40:41], v[40:41], v[90:91]
    v_pk_add_f32 v[42:43], v[42:43], v[92:93]
    v_cvt_pk_bf16_f32 v96, v16, v17
    v_cvt_pk_bf16_f32 v97, v18, v19
    v_cvt_pk_bf16_f32 v98, v24, v25
    v_cvt_pk_bf16_f32 v99, v26, v27
    v_cvt_pk_bf16_f32 v100, v32, v33
    v_cvt_pk_bf16_f32 v101, v34, v35
    v_cvt_pk_bf16_f32 v102, v40, v41
    v_cvt_pk_bf16_f32 v103, v42, v43
    v_dot2c_f32_bf16 v112, s34, v96
    v_dot2c_f32_bf16 v113, v96, v96
    v_dot2c_f32_bf16 v112, s34, v97
    v_dot2c_f32_bf16 v113, v97, v97
    v_dot2c_f32_bf16 v112, s34, v98
    v_dot2c_f32_bf16 v113, v98, v98
    v_dot2c_f32_bf16 v112, s34, v99
    v_dot2c_f32_bf16 v113, v99, v99
    v_dot2c_f32_bf16 v112, s34, v100
    v_dot2c_f32_bf16 v113, v100, v100
    v_dot2c_f32_bf16 v112, s34, v101
    v_dot2c_f32_bf16 v113, v101, v101
    v_dot2c_f32_bf16 v112, s34, v102
    v_dot2c_f32_bf16 v113, v102, v102
    v_dot2c_f32_bf16 v112, s34, v103
    v_dot2c_f32_bf16 v113, v103, v103
    v_permlane32_swap_b32 v96, v98
    v_permlane32_swap_b32 v97, v99
    s_nop 0
    v_permlane16_swap_b32 v96, v98
    v_permlane16_swap_b32 v97, v99
    buffer_store_dwordx4 v[96:99], v84, s[12:15], s64 offen offset:0 sc1
    v_permlane32_swap_b32 v100, v102
    v_permlane32_swap_b32 v101, v103
    s_nop 0
    v_permlane16_swap_b32 v100, v102
    v_permlane16_swap_b32 v101, v103
    buffer_store_dwordx4 v[100:103], v84, s[12:15], s65 offen offset:0 sc1
    s_waitcnt lgkmcnt(0)
    v_lshlrev_b32 v86, 16, v72
    v_and_b32 v87, 0xffff0000, v72
    v_lshlrev_b32 v88, 16, v73
    v_and_b32 v89, 0xffff0000, v73
    v_pk_add_f32 v[20:21], v[20:21], v[86:87]
    v_pk_add_f32 v[22:23], v[22:23], v[88:89]
    v_lshlrev_b32 v90, 16, v74
    v_and_b32 v91, 0xffff0000, v74
    v_lshlrev_b32 v92, 16, v75
    v_and_b32 v93, 0xffff0000, v75
    v_pk_add_f32 v[28:29], v[28:29], v[90:91]
    v_pk_add_f32 v[30:31], v[30:31], v[92:93]
    v_lshlrev_b32 v86, 16, v76
    v_and_b32 v87, 0xffff0000, v76
    v_lshlrev_b32 v88, 16, v77
    v_and_b32 v89, 0xffff0000, v77
    v_pk_add_f32 v[36:37], v[36:37], v[86:87]
    v_pk_add_f32 v[38:39], v[38:39], v[88:89]
    v_lshlrev_b32 v90, 16, v78
    v_and_b32 v91, 0xffff0000, v78
    v_lshlrev_b32 v92, 16, v79
    v_and_b32 v93, 0xffff0000, v79
    v_pk_add_f32 v[44:45], v[44:45], v[90:91]
    v_pk_add_f32 v[46:47], v[46:47], v[92:93]
    v_cvt_pk_bf16_f32 v104, v20, v21
    v_cvt_pk_bf16_f32 v105, v22, v23
    v_cvt_pk_bf16_f32 v106, v28, v29
    v_cvt_pk_bf16_f32 v107, v30, v31
    v_cvt_pk_bf16_f32 v108, v36, v37
    v_cvt_pk_bf16_f32 v109, v38, v39
    v_cvt_pk_bf16_f32 v110, v44, v45
    v_cvt_pk_bf16_f32 v111, v46, v47
    v_dot2c_f32_bf16 v114, s34, v104
    v_dot2c_f32_bf16 v115, v104, v104
    v_dot2c_f32_bf16 v114, s34, v105
    v_dot2c_f32_bf16 v115, v105, v105
    v_dot2c_f32_bf16 v114, s34, v106
    v_dot2c_f32_bf16 v115, v106, v106
    v_dot2c_f32_bf16 v114, s34, v107
    v_dot2c_f32_bf16 v115, v107, v107
    v_dot2c_f32_bf16 v114, s34, v108
    v_dot2c_f32_bf16 v115, v108, v108
    v_dot2c_f32_bf16 v114, s34, v109
    v_dot2c_f32_bf16 v115, v109, v109
    v_dot2c_f32_bf16 v114, s34, v110
    v_dot2c_f32_bf16 v115, v110, v110
    v_dot2c_f32_bf16 v114, s34, v111
    v_dot2c_f32_bf16 v115, v111, v111
    v_permlane32_swap_b32 v104, v106
    v_permlane32_swap_b32 v105, v107
    s_nop 0
    v_permlane16_swap_b32 v104, v106
    v_permlane16_swap_b32 v105, v107
    buffer_store_dwordx4 v[104:107], v84, s[12:15], s64 offen offset:1024 sc1
    v_permlane32_swap_b32 v108, v110
    v_permlane32_swap_b32 v109, v111
    s_nop 0
    v_permlane16_swap_b32 v108, v110
    v_permlane16_swap_b32 v109, v111
    buffer_store_dwordx4 v[108:111], v84, s[12:15], s65 offen offset:1024 sc1
    v_permlane32_swap_b32 v112, v113
    v_permlane32_swap_b32 v114, v115
    s_nop 0
    v_add_f32 v112, v112, v113
    v_add_f32 v114, v114, v115
    s_nop 1
    v_permlane16_swap_b32 v112, v114
    s_nop 0
    v_add_f32 v112, v112, v114
    buffer_store_dword v112, v116, s[20:23], s68 offen sc1
p3_c:
    s_and_b32 s34, s2, 7
    s_lshr_b32 s35, s2, 3
    s_lshr_b32 s39, s35, 3
    s_and_b32 s54, s35, 7
    s_lshr_b32 s36, s34, 1
    s_and_b32 s37, s34, 1
    s_lshl_b32 s25, s36, 2
    s_lshl_b32 s26, s37, 3
    s_add_u32 s25, s25, s39
    s_add_u32 s26, s26, s54
    s_lshr_b32 s27, s24, 1
    s_and_b32 s28, s24, 1
    v_and_b32 v16, 15, v1
    v_lshrrev_b32 v17, 4, v1
    v_bfe_u32 v18, v16, 1, 3
    v_xor_b32 v18, v18, v17
    v_lshlrev_b32 v18, 4, v18
    v_lshl_add_u32 v19, v16, 7, v18
    s_lshl_b32 s34, s27, 1
    s_add_u32 s34, s34, s28
    s_lshl_b32 s34, s34, 12
    v_add_u32 v2, s34, v19
    v_xor_b32 v3, 64, v2
    s_lshl_b32 s34, s27, 1
    s_add_u32 s34, s34, s28
    s_xor_b32 s34, s34, 1
    s_lshl_b32 s34, s34, 12
    v_add_u32 v4, s34, v19
    v_xor_b32 v5, 64, v4
    v_bfe_u32 v18, v1, 2, 2
    v_lshl_add_u32 v18, v17, 3, v18
    v_bfe_u32 v19, v1, 1, 1
    v_and_b32 v20, 1, v1
    v_lshlrev_b32 v20, 3, v20
    v_bfe_u32 v21, v1, 3, 2
    v_lshlrev_b32 v21, 1, v21
    v_xor_b32 v21, v21, v19
    v_lshl_add_u32 v21, v21, 4, v20
    v_lshl_add_u32 v21, v18, 7, v21
    v_bfe_u32 v17, v1, 4, 1
    v_lshlrev_b32 v17, 1, v17
    v_xor_b32 v17, v17, v19
    v_lshl_add_u32 v17, v17, 4, v20
    v_lshl_add_u32 v17, v18, 6, v17
    v_xor_b32 v6, 0, v21
    s_mul_i32 s34, s28, 8192
    s_add_u32 s34, s34, 16384
    v_add_u32 v6, s34, v6
    v_xor_b32 v7, 32, v21
    s_mul_i32 s34, s28, 8192
    s_add_u32 s34, s34, 16384
    v_add_u32 v7, s34, v7
    v_xor_b32 v8, 64, v21
    s_mul_i32 s34, s28, 8192
    s_add_u32 s34, s34, 16384
    v_add_u32 v8, s34, v8
    v_xor_b32 v9, 96, v21
    s_mul_i32 s34, s28, 8192
    s_add_u32 s34, s34, 16384
    v_add_u32 v9, s34, v9
    s_mul_i32 s34, s28, 64
    v_xor_b32 v10, s34, v21
    v_add_u32 v10, 32768, v10
    s_mul_i32 s34, s28, 64
    s_add_u32 s34, s34, 32
    v_xor_b32 v11, s34, v21
    v_add_u32 v11, 32768, v11
    v_xor_b32 v12, 0, v17
    v_add_u32 v12, 40960, v12
    v_xor_b32 v13, 32, v17
    v_add_u32 v13, 40960, v13
    s_add_u32 s12, s92, 0xc00000
    s_addc_u32 s13, s93, 0
    s_mov_b32 s14, 0xe00000
    s_mov_b32 s15, 0x20000
    v_mov_b64 v[16:17], 0
    v_mov_b64 v[18:19], 0
    v_mov_b64 v[20:21], 0
    v_mov_b64 v[22:23], 0
    v_mov_b64 v[24:25], 0
    v_mov_b64 v[26:27], 0
    v_mov_b64 v[28:29], 0
    v_mov_b64 v[30:31], 0
    v_mov_b64 v[32:33], 0
    v_mov_b64 v[34:35], 0
    v_mov_b64 v[36:37], 0
    v_mov_b64 v[38:39], 0
    v_mov_b64 v[40:41], 0
    v_mov_b64 v[42:43], 0
    v_mov_b64 v[44:45], 0
    v_mov_b64 v[46:47], 0
    v_mov_b64 v[48:49], 0
    v_mov_b64 v[50:51], 0
    v_mov_b64 v[52:53], 0
    v_mov_b64 v[54:55], 0
    v_mov_b64 v[56:57], 0
    v_mov_b64 v[58:59], 0
    v_mov_b64 v[60:61], 0
    v_mov_b64 v[62:63], 0
    v_mov_b64 v[64:65], 0
    v_mov_b64 v[66:67], 0
    v_mov_b64 v[68:69], 0
    v_mov_b64 v[70:71], 0
    v_mov_b64 v[72:73], 0
    v_mov_b64 v[74:75], 0
    v_mov_b64 v[76:77], 0
    v_mov_b64 v[78:79], 0
    v_mov_b64 v[80:81], 0
    v_mov_b64 v[82:83], 0
    v_mov_b64 v[84:85], 0
    v_mov_b64 v[86:87], 0
    v_mov_b64 v[88:89], 0
    v_mov_b64 v[90:91], 0
    v_mov_b64 v[92:93], 0
    v_mov_b64 v[94:95], 0
    v_mov_b64 v[96:97], 0
    v_mov_b64 v[98:99], 0
    v_mov_b64 v[100:101], 0
    v_mov_b64 v[102:103], 0
    v_mov_b64 v[104:105], 0
    v_mov_b64 v[106:107], 0
    v_mov_b64 v[108:109], 0
    v_mov_b64 v[110:111], 0
    v_mov_b64 v[112:113], 0
    v_mov_b64 v[114:115], 0
    v_mov_b64 v[116:117], 0
    v_mov_b64 v[118:119], 0
    v_mov_b64 v[120:121], 0
    v_mov_b64 v[122:123], 0
    v_mov_b64 v[124:125], 0
    v_mov_b64 v[126:127], 0
    s_mov_b32 s32, 0
    s_mov_b32 s36, 45056
    s_mov_b32 s37, 4294877184
    s_setprio 3
    s_waitcnt vmcnt(0)
    s_barrier
    s_barrier
    s_barrier
    ds_read_b128 a[0:3], v2 offset:0
    ds_read_b128 a[4:7], v2 offset:2048
    ds_read_b128 a[8:11], v4 offset:0
    ds_read_b128 a[12:15], v4 offset:2048
    ds_read_b64_tr_b16 a[16:17], v6 offset:0
    ds_read_b64_tr_b16 a[18:19], v6 offset:512
    ds_read_b64_tr_b16 a[20:21], v7 offset:0
    ds_read_b64_tr_b16 a[22:23], v7 offset:512
    ds_read_b64_tr_b16 a[24:25], v8 offset:0
    ds_read_b64_tr_b16 a[26:27], v8 offset:512
    ds_read_b64_tr_b16 a[28:29], v9 offset:0
    ds_read_b64_tr_b16 a[30:31], v9 offset:512
    ds_read_b64_tr_b16 a[32:33], v10 offset:0
    ds_read_b64_tr_b16 a[34:35], v10 offset:512
    ds_read_b64_tr_b16 a[36:37], v11 offset:0
    ds_read_b64_tr_b16 a[38:39], v11 offset:512
    ds_read_b64_tr_b16 a[40:41], v12 offset:0
    ds_read_b64_tr_b16 a[42:43], v12 offset:256
    ds_read_b64_tr_b16 a[44:45], v13 offset:0
    ds_read_b64_tr_b16 a[46:47], v13 offset:256
    s_mov_b32 s31, 16
Lc_8:
    s_waitcnt lgkmcnt(0)
    v_mfma_f32_16x16x32_bf16 v[16:19], a[16:19], a[0:3], v[16:19]
    ds_read_b128 a[48:51], v3 offset:0
    v_mfma_f32_16x16x32_bf16 v[20:23], a[16:19], a[4:7], v[20:23]
    ds_read_b128 a[52:55], v3 offset:2048
    v_mfma_f32_16x16x32_bf16 v[24:27], a[16:19], a[8:11], v[24:27]
    ds_read_b128 a[56:59], v5 offset:0
    v_mfma_f32_16x16x32_bf16 v[28:31], a[16:19], a[12:15], v[28:31]
    ds_read_b128 a[60:63], v5 offset:2048
    v_mfma_f32_16x16x32_bf16 v[32:35], a[20:23], a[0:3], v[32:35]
    ds_read_b64_tr_b16 a[64:65], v6 offset:4096
    v_mfma_f32_16x16x32_bf16 v[36:39], a[20:23], a[4:7], v[36:39]
    ds_read_b64_tr_b16 a[66:67], v6 offset:4608
    v_mfma_f32_16x16x32_bf16 v[40:43], a[20:23], a[8:11], v[40:43]
    ds_read_b64_tr_b16 a[68:69], v7 offset:4096
    v_mfma_f32_16x16x32_bf16 v[44:47], a[20:23], a[12:15], v[44:47]
    ds_read_b64_tr_b16 a[70:71], v7 offset:4608
    v_mfma_f32_16x16x32_bf16 v[48:51], a[24:27], a[0:3], v[48:51]
    ds_read_b64_tr_b16 a[72:73], v8 offset:4096
    v_mfma_f32_16x16x32_bf16 v[52:55], a[24:27], a[4:7], v[52:55]
    ds_read_b64_tr_b16 a[74:75], v8 offset:4608
    v_mfma_f32_16x16x32_bf16 v[56:59], a[24:27], a[8:11], v[56:59]
    ds_read_b64_tr_b16 a[76:77], v9 offset:4096
    v_mfma_f32_16x16x32_bf16 v[60:63], a[24:27], a[12:15], v[60:63]
    ds_read_b64_tr_b16 a[78:79], v9 offset:4608
    v_mfma_f32_16x16x32_bf16 v[64:67], a[28:31], a[0:3], v[64:67]
    ds_read_b64_tr_b16 a[80:81], v10 offset:4096
    v_mfma_f32_16x16x32_bf16 v[68:71], a[28:31], a[4:7], v[68:71]
    ds_read_b64_tr_b16 a[82:83], v10 offset:4608
    v_mfma_f32_16x16x32_bf16 v[72:75], a[28:31], a[8:11], v[72:75]
    ds_read_b64_tr_b16 a[84:85], v11 offset:4096
    v_mfma_f32_16x16x32_bf16 v[76:79], a[28:31], a[12:15], v[76:79]
    ds_read_b64_tr_b16 a[86:87], v11 offset:4608
    v_mfma_f32_16x16x32_bf16 v[80:83], a[32:35], a[0:3], v[80:83]
    ds_read_b64_tr_b16 v[140:141], v12 offset:2048
    v_mfma_f32_16x16x32_bf16 v[84:87], a[32:35], a[4:7], v[84:87]
    ds_read_b64_tr_b16 v[142:143], v12 offset:2304
    v_mfma_f32_16x16x32_bf16 v[88:91], a[32:35], a[8:11], v[88:91]
    ds_read_b64_tr_b16 v[144:145], v13 offset:2048
    v_mfma_f32_16x16x32_bf16 v[92:95], a[32:35], a[12:15], v[92:95]
    ds_read_b64_tr_b16 v[146:147], v13 offset:2304
    v_mfma_f32_16x16x32_bf16 v[96:99], a[36:39], a[0:3], v[96:99]
    s_add_u32 s32, s32, 45056
    s_cmp_eq_u32 s32, 135168
    v_mfma_f32_16x16x32_bf16 v[100:103], a[36:39], a[4:7], v[100:103]
    s_cselect_b32 s33, s37, s36
    s_cselect_b32 s32, 0, s32
    v_mfma_f32_16x16x32_bf16 v[104:107], a[36:39], a[8:11], v[104:107]
    v_add_u32 v2, s33, v2
    v_add_u32 v4, s33, v4
    v_mfma_f32_16x16x32_bf16 v[108:111], a[36:39], a[12:15], v[108:111]
    v_add_u32 v6, s33, v6
    v_add_u32 v7, s33, v7
    v_mfma_f32_16x16x32_bf16 v[112:115], a[40:43], a[0:3], v[112:115]
    v_add_u32 v8, s33, v8
    v_add_u32 v9, s33, v9
    v_mfma_f32_16x16x32_bf16 v[116:119], a[40:43], a[4:7], v[116:119]
    v_add_u32 v10, s33, v10
    v_add_u32 v11, s33, v11
    v_mfma_f32_16x16x32_bf16 v[120:123], a[44:47], a[0:3], v[120:123]
    v_add_u32 v12, s33, v12
    v_mfma_f32_16x16x32_bf16 v[124:127], a[44:47], a[4:7], v[124:127]
    v_add_u32 v13, s33, v13
    s_waitcnt lgkmcnt(0)
    s_barrier
    v_mfma_f32_16x16x32_bf16 v[16:19], a[64:67], a[48:51], v[16:19]
    ds_read_b128 a[0:3], v2 offset:0
    v_mfma_f32_16x16x32_bf16 v[20:23], a[64:67], a[52:55], v[20:23]
    ds_read_b128 a[4:7], v2 offset:2048
    v_mfma_f32_16x16x32_bf16 v[24:27], a[64:67], a[56:59], v[24:27]
    ds_read_b128 a[8:11], v4 offset:0
    v_mfma_f32_16x16x32_bf16 v[28:31], a[64:67], a[60:63], v[28:31]
    ds_read_b128 a[12:15], v4 offset:2048
    v_mfma_f32_16x16x32_bf16 v[32:35], a[68:71], a[48:51], v[32:35]
    ds_read_b64_tr_b16 a[16:17], v6 offset:0
    v_mfma_f32_16x16x32_bf16 v[36:39], a[68:71], a[52:55], v[36:39]
    ds_read_b64_tr_b16 a[18:19], v6 offset:512
    v_mfma_f32_16x16x32_bf16 v[40:43], a[68:71], a[56:59], v[40:43]
    ds_read_b64_tr_b16 a[20:21], v7 offset:0
    v_mfma_f32_16x16x32_bf16 v[44:47], a[68:71], a[60:63], v[44:47]
    ds_read_b64_tr_b16 a[22:23], v7 offset:512
    v_mfma_f32_16x16x32_bf16 v[48:51], a[72:75], a[48:51], v[48:51]
    ds_read_b64_tr_b16 a[24:25], v8 offset:0
    v_mfma_f32_16x16x32_bf16 v[52:55], a[72:75], a[52:55], v[52:55]
    ds_read_b64_tr_b16 a[26:27], v8 offset:512
    v_mfma_f32_16x16x32_bf16 v[56:59], a[72:75], a[56:59], v[56:59]
    ds_read_b64_tr_b16 a[28:29], v9 offset:0
    v_mfma_f32_16x16x32_bf16 v[60:63], a[72:75], a[60:63], v[60:63]
    ds_read_b64_tr_b16 a[30:31], v9 offset:512
    v_mfma_f32_16x16x32_bf16 v[64:67], a[76:79], a[48:51], v[64:67]
    ds_read_b64_tr_b16 a[32:33], v10 offset:0
    v_mfma_f32_16x16x32_bf16 v[68:71], a[76:79], a[52:55], v[68:71]
    ds_read_b64_tr_b16 a[34:35], v10 offset:512
    v_mfma_f32_16x16x32_bf16 v[72:75], a[76:79], a[56:59], v[72:75]
    ds_read_b64_tr_b16 a[36:37], v11 offset:0
    v_mfma_f32_16x16x32_bf16 v[76:79], a[76:79], a[60:63], v[76:79]
    ds_read_b64_tr_b16 a[38:39], v11 offset:512
    v_mfma_f32_16x16x32_bf16 v[80:83], a[80:83], a[48:51], v[80:83]
    ds_read_b64_tr_b16 a[40:41], v12 offset:0
    v_mfma_f32_16x16x32_bf16 v[84:87], a[80:83], a[52:55], v[84:87]
    ds_read_b64_tr_b16 a[42:43], v12 offset:256
    v_mfma_f32_16x16x32_bf16 v[88:91], a[80:83], a[56:59], v[88:91]
    ds_read_b64_tr_b16 a[44:45], v13 offset:0
    v_mfma_f32_16x16x32_bf16 v[92:95], a[80:83], a[60:63], v[92:95]
    ds_read_b64_tr_b16 a[46:47], v13 offset:256
    v_mfma_f32_16x16x32_bf16 v[96:99], a[84:87], a[48:51], v[96:99]
    v_add_u32 v3, s33, v3
    v_mfma_f32_16x16x32_bf16 v[100:103], a[84:87], a[52:55], v[100:103]
    v_add_u32 v5, s33, v5
    v_mfma_f32_16x16x32_bf16 v[104:107], a[84:87], a[56:59], v[104:107]
    s_sub_u32 s31, s31, 1
    v_mfma_f32_16x16x32_bf16 v[108:111], a[84:87], a[60:63], v[108:111]
    s_cmp_lg_u32 s31, 0
    v_mfma_f32_16x16x32_bf16 v[112:115], v[140:143], a[48:51], v[112:115]
    v_mfma_f32_16x16x32_bf16 v[116:119], v[140:143], a[52:55], v[116:119]
    v_mfma_f32_16x16x32_bf16 v[120:123], v[144:147], a[48:51], v[120:123]
    v_mfma_f32_16x16x32_bf16 v[124:127], v[144:147], a[52:55], v[124:127]
    s_cbranch_scc1 Lc_8
    s_waitcnt lgkmcnt(0)
    s_setprio 0
    s_barrier
    s_nop 7
p3_epi:
    v_and_b32 v2, 15, v1
    v_lshrrev_b32 v3, 4, v1
    s_lshl_b32 s34, s27, 1
    s_add_u32 s34, s34, s28
    s_lshl_b32 s35, s34, 7
    s_add_u32 s35, s35, 135168
    v_lshlrev_b32 v4, 2, v2
    v_add_u32 v4, s35, v4
    v_xor_b32 v10, 128, v4
    v_lshlrev_b32 v5, 4, v3
    v_add_u32 v5, 136192, v5
    s_lshl_b32 s35, s28, 8
    v_add_u32 v6, s35, v5
    s_lshl_b32 s35, s28, 7
    v_add_u32 v7, s35, v5
    ds_read2_b32 v[128:129], v4 offset0:0 offset1:128
    ds_read2_b32 v[130:131], v4 offset0:16 offset1:144
    ds_read2_b32 v[132:133], v10 offset0:0 offset1:128
    ds_read2_b32 v[134:135], v10 offset0:16 offset1:144
    ds_read_b128 v[136:139], v6 offset:0
    ds_read_b128 v[140:143], v6 offset:64
    ds_read_b128 v[144:147], v6 offset:128
    ds_read_b128 v[148:151], v6 offset:192
    ds_read_b128 v[152:155], v7 offset:512
    ds_read_b128 v[156:159], v7 offset:576
    ds_read_b128 v[160:163], v5 offset:768
    ds_read_b128 v[164:167], v5 offset:832
    v_lshlrev_b32 v5, 6, v2
    v_lshl_add_u32 v5, v3, 4, v5
    s_lshl_b32 s34, s34, 11
    v_add_u32 v5, s34, v5
    v_xor_b32 v6, 0x800, v5
    s_mul_i32 s34, s25, 112
    s_mul_i32 s35, s26, 7
    s_add_u32 s34, s34, s35
    s_add_u32 s67, s34, 6
    s_bitcmp1_b32 s26, 0
    s_cselect_b32 s67, s34, s67
    s_addc_u32 s34, s34, 0
    s_add_u32 s66, s34, s28
    s_add_u32 s64, s66, s28
    s_add_u32 s66, s66, 4
    s_add_u32 s65, s64, 1
    s_lshl_b32 s64, s64, 13
    s_lshl_b32 s65, s65, 13
    s_lshl_b32 s66, s66, 13
    s_lshl_b32 s67, s67, 13
    s_mov_b32 s68, 0xbfb8aa3b
    s_mov_b32 s69, s68
    s_waitcnt lgkmcnt(0)
    v_pk_fma_f32 v[16:17], v[136:137], v[128:129], v[16:17] op_sel:[0,1,0] op_sel_hi:[1,1,1]
    v_pk_fma_f32 v[18:19], v[138:139], v[128:129], v[18:19] op_sel:[0,1,0] op_sel_hi:[1,1,1]
    v_pk_fma_f32 v[32:33], v[140:141], v[128:129], v[32:33] op_sel:[0,1,0] op_sel_hi:[1,1,1]
    v_pk_fma_f32 v[34:35], v[142:143], v[128:129], v[34:35] op_sel:[0,1,0] op_sel_hi:[1,1,1]
    v_pk_mul_f32 v[16:17], v[16:17], v[128:129] op_sel_hi:[1,0]
    v_pk_mul_f32 v[18:19], v[18:19], v[128:129] op_sel_hi:[1,0]
    v_pk_mul_f32 v[32:33], v[32:33], v[128:129] op_sel_hi:[1,0]
    v_pk_mul_f32 v[34:35], v[34:35], v[128:129] op_sel_hi:[1,0]
    v_pk_mul_f32 v[8:9], v[16:17], s[68:69]
    v_pk_mul_f32 v[10:11], v[18:19], s[68:69]
    v_pk_mul_f32 v[12:13], v[32:33], s[68:69]
    v_pk_mul_f32 v[14:15], v[34:35], s[68:69]
    v_exp_f32 v8, v8
    v_exp_f32 v9, v9
    v_exp_f32 v10, v10
    v_exp_f32 v11, v11
    v_exp_f32 v12, v12
    v_exp_f32 v13, v13
    v_exp_f32 v14, v14
    v_exp_f32 v15, v15
    v_pk_add_f32 v[8:9], v[8:9], 1.0 op_sel_hi:[1,0]
    v_pk_add_f32 v[10:11], v[10:11], 1.0 op_sel_hi:[1,0]
    v_pk_add_f32 v[12:13], v[12:13], 1.0 op_sel_hi:[1,0]
    v_pk_add_f32 v[14:15], v[14:15], 1.0 op_sel_hi:[1,0]
    v_rcp_f32 v8, v8
    v_rcp_f32 v9, v9
    v_rcp_f32 v10, v10
    v_rcp_f32 v11, v11
    v_rcp_f32 v12, v12
    v_rcp_f32 v13, v13
    v_rcp_f32 v14, v14
    v_rcp_f32 v15, v15
    v_pk_mul_f32 v[16:17], v[16:17], v[8:9]
    v_pk_mul_f32 v[18:19], v[18:19], v[10:11]
    v_pk_mul_f32 v[32:33], v[32:33], v[12:13]
    v_pk_mul_f32 v[34:35], v[34:35], v[14:15]
    v_cvt_pk_bf16_f32 v16, v16, v17
    v_cvt_pk_bf16_f32 v17, v18, v19
    v_cvt_pk_bf16_f32 v18, v32, v33
    v_cvt_pk_bf16_f32 v19, v34, v35
    v_pk_fma_f32 v[20:21], v[136:137], v[130:131], v[20:21] op_sel:[0,1,0] op_sel_hi:[1,1,1]
    v_pk_fma_f32 v[22:23], v[138:139], v[130:131], v[22:23] op_sel:[0,1,0] op_sel_hi:[1,1,1]
    v_pk_fma_f32 v[36:37], v[140:141], v[130:131], v[36:37] op_sel:[0,1,0] op_sel_hi:[1,1,1]
    v_pk_fma_f32 v[38:39], v[142:143], v[130:131], v[38:39] op_sel:[0,1,0] op_sel_hi:[1,1,1]
    v_permlane32_swap_b32 v16, v18
    v_permlane32_swap_b32 v17, v19
    s_nop 0
    v_permlane16_swap_b32 v16, v18
    v_permlane16_swap_b32 v17, v19
    buffer_store_dwordx4 v[16:19], v5, s[12:15], s64 offen offset:0 sc1
    v_pk_mul_f32 v[20:21], v[20:21], v[130:131] op_sel_hi:[1,0]
    v_pk_mul_f32 v[22:23], v[22:23], v[130:131] op_sel_hi:[1,0]
    v_pk_mul_f32 v[36:37], v[36:37], v[130:131] op_sel_hi:[1,0]
    v_pk_mul_f32 v[38:39], v[38:39], v[130:131] op_sel_hi:[1,0]
    v_pk_mul_f32 v[8:9], v[20:21], s[68:69]
    v_pk_mul_f32 v[10:11], v[22:23], s[68:69]
    v_pk_mul_f32 v[12:13], v[36:37], s[68:69]
    v_pk_mul_f32 v[14:15], v[38:39], s[68:69]
    v_exp_f32 v8, v8
    v_exp_f32 v9, v9
    v_exp_f32 v10, v10
    v_exp_f32 v11, v11
    v_exp_f32 v12, v12
    v_exp_f32 v13, v13
    v_exp_f32 v14, v14
    v_exp_f32 v15, v15
    v_pk_add_f32 v[8:9], v[8:9], 1.0 op_sel_hi:[1,0]
    v_pk_add_f32 v[10:11], v[10:11], 1.0 op_sel_hi:[1,0]
    v_pk_add_f32 v[12:13], v[12:13], 1.0 op_sel_hi:[1,0]
    v_pk_add_f32 v[14:15], v[14:15], 1.0 op_sel_hi:[1,0]
    v_rcp_f32 v8, v8
    v_rcp_f32 v9, v9
    v_rcp_f32 v10, v10
    v_rcp_f32 v11, v11
    v_rcp_f32 v12, v12
    v_rcp_f32 v13, v13
    v_rcp_f32 v14, v14
    v_rcp_f32 v15, v15
    v_pk_mul_f32 v[20:21], v[20:21], v[8:9]
    v_pk_mul_f32 v[22:23], v[22:23], v[10:11]
    v_pk_mul_f32 v[36:37], v[36:37], v[12:13]
    v_pk_mul_f32 v[38:39], v[38:39], v[14:15]
    v_cvt_pk_bf16_f32 v20, v20, v21
    v_cvt_pk_bf16_f32 v21, v22, v23
    v_cvt_pk_bf16_f32 v22, v36, v37
    v_cvt_pk_bf16_f32 v23, v38, v39
    v_pk_fma_f32 v[24:25], v[136:137], v[132:133], v[24:25] op_sel:[0,1,0] op_sel_hi:[1,1,1]
    v_pk_fma_f32 v[26:27], v[138:139], v[132:133], v[26:27] op_sel:[0,1,0] op_sel_hi:[1,1,1]
    v_pk_fma_f32 v[40:41], v[140:141], v[132:133], v[40:41] op_sel:[0,1,0] op_sel_hi:[1,1,1]
    v_pk_fma_f32 v[42:43], v[142:143], v[132:133], v[42:43] op_sel:[0,1,0] op_sel_hi:[1,1,1]
    v_permlane32_swap_b32 v20, v22
    v_permlane32_swap_b32 v21, v23
    s_nop 0
    v_permlane16_swap_b32 v20, v22
    v_permlane16_swap_b32 v21, v23
    buffer_store_dwordx4 v[20:23], v5, s[12:15], s64 offen offset:1024 sc1
    v_pk_mul_f32 v[24:25], v[24:25], v[132:133] op_sel_hi:[1,0]
    v_pk_mul_f32 v[26:27], v[26:27], v[132:133] op_sel_hi:[1,0]
    v_pk_mul_f32 v[40:41], v[40:41], v[132:133] op_sel_hi:[1,0]
    v_pk_mul_f32 v[42:43], v[42:43], v[132:133] op_sel_hi:[1,0]
    v_pk_mul_f32 v[8:9], v[24:25], s[68:69]
    v_pk_mul_f32 v[10:11], v[26:27], s[68:69]
    v_pk_mul_f32 v[12:13], v[40:41], s[68:69]
    v_pk_mul_f32 v[14:15], v[42:43], s[68:69]
    v_exp_f32 v8, v8
    v_exp_f32 v9, v9
    v_exp_f32 v10, v10
    v_exp_f32 v11, v11
    v_exp_f32 v12, v12
    v_exp_f32 v13, v13
    v_exp_f32 v14, v14
    v_exp_f32 v15, v15
    v_pk_add_f32 v[8:9], v[8:9], 1.0 op_sel_hi:[1,0]
    v_pk_add_f32 v[10:11], v[10:11], 1.0 op_sel_hi:[1,0]
    v_pk_add_f32 v[12:13], v[12:13], 1.0 op_sel_hi:[1,0]
    v_pk_add_f32 v[14:15], v[14:15], 1.0 op_sel_hi:[1,0]
    v_rcp_f32 v8, v8
    v_rcp_f32 v9, v9
    v_rcp_f32 v10, v10
    v_rcp_f32 v11, v11
    v_rcp_f32 v12, v12
    v_rcp_f32 v13, v13
    v_rcp_f32 v14, v14
    v_rcp_f32 v15, v15
    v_pk_mul_f32 v[24:25], v[24:25], v[8:9]
    v_pk_mul_f32 v[26:27], v[26:27], v[10:11]
    v_pk_mul_f32 v[40:41], v[40:41], v[12:13]
    v_pk_mul_f32 v[42:43], v[42:43], v[14:15]
    v_cvt_pk_bf16_f32 v24, v24, v25
    v_cvt_pk_bf16_f32 v25, v26, v27
    v_cvt_pk_bf16_f32 v26, v40, v41
    v_cvt_pk_bf16_f32 v27, v42, v43
    v_pk_fma_f32 v[28:29], v[136:137], v[134:135], v[28:29] op_sel:[0,1,0] op_sel_hi:[1,1,1]
    v_pk_fma_f32 v[30:31], v[138:139], v[134:135], v[30:31] op_sel:[0,1,0] op_sel_hi:[1,1,1]
    v_pk_fma_f32 v[44:45], v[140:141], v[134:135], v[44:45] op_sel:[0,1,0] op_sel_hi:[1,1,1]
    v_pk_fma_f32 v[46:47], v[142:143], v[134:135], v[46:47] op_sel:[0,1,0] op_sel_hi:[1,1,1]
    v_permlane32_swap_b32 v24, v26
    v_permlane32_swap_b32 v25, v27
    s_nop 0
    v_permlane16_swap_b32 v24, v26
    v_permlane16_swap_b32 v25, v27
    buffer_store_dwordx4 v[24:27], v6, s[12:15], s64 offen offset:0 sc1
    v_pk_mul_f32 v[28:29], v[28:29], v[134:135] op_sel_hi:[1,0]
    v_pk_mul_f32 v[30:31], v[30:31], v[134:135] op_sel_hi:[1,0]
    v_pk_mul_f32 v[44:45], v[44:45], v[134:135] op_sel_hi:[1,0]
    v_pk_mul_f32 v[46:47], v[46:47], v[134:135] op_sel_hi:[1,0]
    v_pk_mul_f32 v[8:9], v[28:29], s[68:69]
    v_pk_mul_f32 v[10:11], v[30:31], s[68:69]
    v_pk_mul_f32 v[12:13], v[44:45], s[68:69]
    v_pk_mul_f32 v[14:15], v[46:47], s[68:69]
    v_exp_f32 v8, v8
    v_exp_f32 v9, v9
    v_exp_f32 v10, v10
    v_exp_f32 v11, v11
    v_exp_f32 v12, v12
    v_exp_f32 v13, v13
    v_exp_f32 v14, v14
    v_exp_f32 v15, v15
    v_pk_add_f32 v[8:9], v[8:9], 1.0 op_sel_hi:[1,0]
    v_pk_add_f32 v[10:11], v[10:11], 1.0 op_sel_hi:[1,0]
    v_pk_add_f32 v[12:13], v[12:13], 1.0 op_sel_hi:[1,0]
    v_pk_add_f32 v[14:15], v[14:15], 1.0 op_sel_hi:[1,0]
    v_rcp_f32 v8, v8
    v_rcp_f32 v9, v9
    v_rcp_f32 v10, v10
    v_rcp_f32 v11, v11
    v_rcp_f32 v12, v12
    v_rcp_f32 v13, v13
    v_rcp_f32 v14, v14
    v_rcp_f32 v15, v15
    v_pk_mul_f32 v[28:29], v[28:29], v[8:9]
    v_pk_mul_f32 v[30:31], v[30:31], v[10:11]
    v_pk_mul_f32 v[44:45], v[44:45], v[12:13]
    v_pk_mul_f32 v[46:47], v[46:47], v[14:15]
    v_cvt_pk_bf16_f32 v28, v28, v29
    v_cvt_pk_bf16_f32 v29, v30, v31
    v_cvt_pk_bf16_f32 v30, v44, v45
    v_cvt_pk_bf16_f32 v31, v46, v47
    v_pk_fma_f32 v[48:49], v[144:145], v[128:129], v[48:49] op_sel:[0,1,0] op_sel_hi:[1,1,1]
    v_pk_fma_f32 v[50:51], v[146:147], v[128:129], v[50:51] op_sel:[0,1,0] op_sel_hi:[1,1,1]
    v_pk_fma_f32 v[64:65], v[148:149], v[128:129], v[64:65] op_sel:[0,1,0] op_sel_hi:[1,1,1]
    v_pk_fma_f32 v[66:67], v[150:151], v[128:129], v[66:67] op_sel:[0,1,0] op_sel_hi:[1,1,1]
    v_permlane32_swap_b32 v28, v30
    v_permlane32_swap_b32 v29, v31
    s_nop 0
    v_permlane16_swap_b32 v28, v30
    v_permlane16_swap_b32 v29, v31
    buffer_store_dwordx4 v[28:31], v6, s[12:15], s64 offen offset:1024 sc1
    v_pk_mul_f32 v[48:49], v[48:49], v[128:129] op_sel_hi:[1,0]
    v_pk_mul_f32 v[50:51], v[50:51], v[128:129] op_sel_hi:[1,0]
    v_pk_mul_f32 v[64:65], v[64:65], v[128:129] op_sel_hi:[1,0]
    v_pk_mul_f32 v[66:67], v[66:67], v[128:129] op_sel_hi:[1,0]
    v_pk_mul_f32 v[8:9], v[48:49], s[68:69]
    v_pk_mul_f32 v[10:11], v[50:51], s[68:69]
    v_pk_mul_f32 v[12:13], v[64:65], s[68:69]
    v_pk_mul_f32 v[14:15], v[66:67], s[68:69]
    v_exp_f32 v8, v8
    v_exp_f32 v9, v9
    v_exp_f32 v10, v10
    v_exp_f32 v11, v11
    v_exp_f32 v12, v12
    v_exp_f32 v13, v13
    v_exp_f32 v14, v14
    v_exp_f32 v15, v15
    v_pk_add_f32 v[8:9], v[8:9], 1.0 op_sel_hi:[1,0]
    v_pk_add_f32 v[10:11], v[10:11], 1.0 op_sel_hi:[1,0]
    v_pk_add_f32 v[12:13], v[12:13], 1.0 op_sel_hi:[1,0]
    v_pk_add_f32 v[14:15], v[14:15], 1.0 op_sel_hi:[1,0]
    v_rcp_f32 v8, v8
    v_rcp_f32 v9, v9
    v_rcp_f32 v10, v10
    v_rcp_f32 v11, v11
    v_rcp_f32 v12, v12
    v_rcp_f32 v13, v13
    v_rcp_f32 v14, v14
    v_rcp_f32 v15, v15
    v_pk_mul_f32 v[48:49], v[48:49], v[8:9]
    v_pk_mul_f32 v[50:51], v[50:51], v[10:11]
    v_pk_mul_f32 v[64:65], v[64:65], v[12:13]
    v_pk_mul_f32 v[66:67], v[66:67], v[14:15]
    v_cvt_pk_bf16_f32 v48, v48, v49
    v_cvt_pk_bf16_f32 v49, v50, v51
    v_cvt_pk_bf16_f32 v50, v64, v65
    v_cvt_pk_bf16_f32 v51, v66, v67
    v_pk_fma_f32 v[52:53], v[144:145], v[130:131], v[52:53] op_sel:[0,1,0] op_sel_hi:[1,1,1]
    v_pk_fma_f32 v[54:55], v[146:147], v[130:131], v[54:55] op_sel:[0,1,0] op_sel_hi:[1,1,1]
    v_pk_fma_f32 v[68:69], v[148:149], v[130:131], v[68:69] op_sel:[0,1,0] op_sel_hi:[1,1,1]
    v_pk_fma_f32 v[70:71], v[150:151], v[130:131], v[70:71] op_sel:[0,1,0] op_sel_hi:[1,1,1]
    v_permlane32_swap_b32 v48, v50
    v_permlane32_swap_b32 v49, v51
    s_nop 0
    v_permlane16_swap_b32 v48, v50
    v_permlane16_swap_b32 v49, v51
    buffer_store_dwordx4 v[48:51], v5, s[12:15], s65 offen offset:0 sc1
    v_pk_mul_f32 v[52:53], v[52:53], v[130:131] op_sel_hi:[1,0]
    v_pk_mul_f32 v[54:55], v[54:55], v[130:131] op_sel_hi:[1,0]
    v_pk_mul_f32 v[68:69], v[68:69], v[130:131] op_sel_hi:[1,0]
    v_pk_mul_f32 v[70:71], v[70:71], v[130:131] op_sel_hi:[1,0]
    v_pk_mul_f32 v[8:9], v[52:53], s[68:69]
    v_pk_mul_f32 v[10:11], v[54:55], s[68:69]
    v_pk_mul_f32 v[12:13], v[68:69], s[68:69]
    v_pk_mul_f32 v[14:15], v[70:71], s[68:69]
    v_exp_f32 v8, v8
    v_exp_f32 v9, v9
    v_exp_f32 v10, v10
    v_exp_f32 v11, v11
    v_exp_f32 v12, v12
    v_exp_f32 v13, v13
    v_exp_f32 v14, v14
    v_exp_f32 v15, v15
    v_pk_add_f32 v[8:9], v[8:9], 1.0 op_sel_hi:[1,0]
    v_pk_add_f32 v[10:11], v[10:11], 1.0 op_sel_hi:[1,0]
    v_pk_add_f32 v[12:13], v[12:13], 1.0 op_sel_hi:[1,0]
    v_pk_add_f32 v[14:15], v[14:15], 1.0 op_sel_hi:[1,0]
    v_rcp_f32 v8, v8
    v_rcp_f32 v9, v9
    v_rcp_f32 v10, v10
    v_rcp_f32 v11, v11
    v_rcp_f32 v12, v12
    v_rcp_f32 v13, v13
    v_rcp_f32 v14, v14
    v_rcp_f32 v15, v15
    v_pk_mul_f32 v[52:53], v[52:53], v[8:9]
    v_pk_mul_f32 v[54:55], v[54:55], v[10:11]
    v_pk_mul_f32 v[68:69], v[68:69], v[12:13]
    v_pk_mul_f32 v[70:71], v[70:71], v[14:15]
    v_cvt_pk_bf16_f32 v52, v52, v53
    v_cvt_pk_bf16_f32 v53, v54, v55
    v_cvt_pk_bf16_f32 v54, v68, v69
    v_cvt_pk_bf16_f32 v55, v70, v71
    v_pk_fma_f32 v[56:57], v[144:145], v[132:133], v[56:57] op_sel:[0,1,0] op_sel_hi:[1,1,1]
    v_pk_fma_f32 v[58:59], v[146:147], v[132:133], v[58:59] op_sel:[0,1,0] op_sel_hi:[1,1,1]
    v_pk_fma_f32 v[72:73], v[148:149], v[132:133], v[72:73] op_sel:[0,1,0] op_sel_hi:[1,1,1]
    v_pk_fma_f32 v[74:75], v[150:151], v[132:133], v[74:75] op_sel:[0,1,0] op_sel_hi:[1,1,1]
    v_permlane32_swap_b32 v52, v54
    v_permlane32_swap_b32 v53, v55
    s_nop 0
    v_permlane16_swap_b32 v52, v54
    v_permlane16_swap_b32 v53, v55
    buffer_store_dwordx4 v[52:55], v5, s[12:15], s65 offen offset:1024 sc1
    v_pk_mul_f32 v[56:57], v[56:57], v[132:133] op_sel_hi:[1,0]
    v_pk_mul_f32 v[58:59], v[58:59], v[132:133] op_sel_hi:[1,0]
    v_pk_mul_f32 v[72:73], v[72:73], v[132:133] op_sel_hi:[1,0]
    v_pk_mul_f32 v[74:75], v[74:75], v[132:133] op_sel_hi:[1,0]
    v_pk_mul_f32 v[8:9], v[56:57], s[68:69]
    v_pk_mul_f32 v[10:11], v[58:59], s[68:69]
    v_pk_mul_f32 v[12:13], v[72:73], s[68:69]
    v_pk_mul_f32 v[14:15], v[74:75], s[68:69]
    v_exp_f32 v8, v8
    v_exp_f32 v9, v9
    v_exp_f32 v10, v10
    v_exp_f32 v11, v11
    v_exp_f32 v12, v12
    v_exp_f32 v13, v13
    v_exp_f32 v14, v14
    v_exp_f32 v15, v15
    v_pk_add_f32 v[8:9], v[8:9], 1.0 op_sel_hi:[1,0]
    v_pk_add_f32 v[10:11], v[10:11], 1.0 op_sel_hi:[1,0]
    v_pk_add_f32 v[12:13], v[12:13], 1.0 op_sel_hi:[1,0]
    v_pk_add_f32 v[14:15], v[14:15], 1.0 op_sel_hi:[1,0]
    v_rcp_f32 v8, v8
    v_rcp_f32 v9, v9
    v_rcp_f32 v10, v10
    v_rcp_f32 v11, v11
    v_rcp_f32 v12, v12
    v_rcp_f32 v13, v13
    v_rcp_f32 v14, v14
    v_rcp_f32 v15, v15
    v_pk_mul_f32 v[56:57], v[56:57], v[8:9]
    v_pk_mul_f32 v[58:59], v[58:59], v[10:11]
    v_pk_mul_f32 v[72:73], v[72:73], v[12:13]
    v_pk_mul_f32 v[74:75], v[74:75], v[14:15]
    v_cvt_pk_bf16_f32 v56, v56, v57
    v_cvt_pk_bf16_f32 v57, v58, v59
    v_cvt_pk_bf16_f32 v58, v72, v73
    v_cvt_pk_bf16_f32 v59, v74, v75
    v_pk_fma_f32 v[60:61], v[144:145], v[134:135], v[60:61] op_sel:[0,1,0] op_sel_hi:[1,1,1]
    v_pk_fma_f32 v[62:63], v[146:147], v[134:135], v[62:63] op_sel:[0,1,0] op_sel_hi:[1,1,1]
    v_pk_fma_f32 v[76:77], v[148:149], v[134:135], v[76:77] op_sel:[0,1,0] op_sel_hi:[1,1,1]
    v_pk_fma_f32 v[78:79], v[150:151], v[134:135], v[78:79] op_sel:[0,1,0] op_sel_hi:[1,1,1]
    v_permlane32_swap_b32 v56, v58
    v_permlane32_swap_b32 v57, v59
    s_nop 0
    v_permlane16_swap_b32 v56, v58
    v_permlane16_swap_b32 v57, v59
    buffer_store_dwordx4 v[56:59], v6, s[12:15], s65 offen offset:0 sc1
    v_pk_mul_f32 v[60:61], v[60:61], v[134:135] op_sel_hi:[1,0]
    v_pk_mul_f32 v[62:63], v[62:63], v[134:135] op_sel_hi:[1,0]
    v_pk_mul_f32 v[76:77], v[76:77], v[134:135] op_sel_hi:[1,0]
    v_pk_mul_f32 v[78:79], v[78:79], v[134:135] op_sel_hi:[1,0]
    v_pk_mul_f32 v[8:9], v[60:61], s[68:69]
    v_pk_mul_f32 v[10:11], v[62:63], s[68:69]
    v_pk_mul_f32 v[12:13], v[76:77], s[68:69]
    v_pk_mul_f32 v[14:15], v[78:79], s[68:69]
    v_exp_f32 v8, v8
    v_exp_f32 v9, v9
    v_exp_f32 v10, v10
    v_exp_f32 v11, v11
    v_exp_f32 v12, v12
    v_exp_f32 v13, v13
    v_exp_f32 v14, v14
    v_exp_f32 v15, v15
    v_pk_add_f32 v[8:9], v[8:9], 1.0 op_sel_hi:[1,0]
    v_pk_add_f32 v[10:11], v[10:11], 1.0 op_sel_hi:[1,0]
    v_pk_add_f32 v[12:13], v[12:13], 1.0 op_sel_hi:[1,0]
    v_pk_add_f32 v[14:15], v[14:15], 1.0 op_sel_hi:[1,0]
    v_rcp_f32 v8, v8
    v_rcp_f32 v9, v9
    v_rcp_f32 v10, v10
    v_rcp_f32 v11, v11
    v_rcp_f32 v12, v12
    v_rcp_f32 v13, v13
    v_rcp_f32 v14, v14
    v_rcp_f32 v15, v15
    v_pk_mul_f32 v[60:61], v[60:61], v[8:9]
    v_pk_mul_f32 v[62:63], v[62:63], v[10:11]
    v_pk_mul_f32 v[76:77], v[76:77], v[12:13]
    v_pk_mul_f32 v[78:79], v[78:79], v[14:15]
    v_cvt_pk_bf16_f32 v60, v60, v61
    v_cvt_pk_bf16_f32 v61, v62, v63
    v_cvt_pk_bf16_f32 v62, v76, v77
    v_cvt_pk_bf16_f32 v63, v78, v79
    v_pk_fma_f32 v[80:81], v[152:153], v[128:129], v[80:81] op_sel:[0,1,0] op_sel_hi:[1,1,1]
    v_pk_fma_f32 v[82:83], v[154:155], v[128:129], v[82:83] op_sel:[0,1,0] op_sel_hi:[1,1,1]
    v_pk_fma_f32 v[96:97], v[156:157], v[128:129], v[96:97] op_sel:[0,1,0] op_sel_hi:[1,1,1]
    v_pk_fma_f32 v[98:99], v[158:159], v[128:129], v[98:99] op_sel:[0,1,0] op_sel_hi:[1,1,1]
    v_permlane32_swap_b32 v60, v62
    v_permlane32_swap_b32 v61, v63
    s_nop 0
    v_permlane16_swap_b32 v60, v62
    v_permlane16_swap_b32 v61, v63
    buffer_store_dwordx4 v[60:63], v6, s[12:15], s65 offen offset:1024 sc1
    v_pk_mul_f32 v[80:81], v[80:81], v[128:129] op_sel_hi:[1,0]
    v_pk_mul_f32 v[82:83], v[82:83], v[128:129] op_sel_hi:[1,0]
    v_pk_mul_f32 v[96:97], v[96:97], v[128:129] op_sel_hi:[1,0]
    v_pk_mul_f32 v[98:99], v[98:99], v[128:129] op_sel_hi:[1,0]
    v_pk_mul_f32 v[8:9], v[80:81], s[68:69]
    v_pk_mul_f32 v[10:11], v[82:83], s[68:69]
    v_pk_mul_f32 v[12:13], v[96:97], s[68:69]
    v_pk_mul_f32 v[14:15], v[98:99], s[68:69]
    v_exp_f32 v8, v8
    v_exp_f32 v9, v9
    v_exp_f32 v10, v10
    v_exp_f32 v11, v11
    v_exp_f32 v12, v12
    v_exp_f32 v13, v13
    v_exp_f32 v14, v14
    v_exp_f32 v15, v15
    v_pk_add_f32 v[8:9], v[8:9], 1.0 op_sel_hi:[1,0]
    v_pk_add_f32 v[10:11], v[10:11], 1.0 op_sel_hi:[1,0]
    v_pk_add_f32 v[12:13], v[12:13], 1.0 op_sel_hi:[1,0]
    v_pk_add_f32 v[14:15], v[14:15], 1.0 op_sel_hi:[1,0]
    v_rcp_f32 v8, v8
    v_rcp_f32 v9, v9
    v_rcp_f32 v10, v10
    v_rcp_f32 v11, v11
    v_rcp_f32 v12, v12
    v_rcp_f32 v13, v13
    v_rcp_f32 v14, v14
    v_rcp_f32 v15, v15
    v_pk_mul_f32 v[80:81], v[80:81], v[8:9]
    v_pk_mul_f32 v[82:83], v[82:83], v[10:11]
    v_pk_mul_f32 v[96:97], v[96:97], v[12:13]
    v_pk_mul_f32 v[98:99], v[98:99], v[14:15]
    v_cvt_pk_bf16_f32 v80, v80, v81
    v_cvt_pk_bf16_f32 v81, v82, v83
    v_cvt_pk_bf16_f32 v82, v96, v97
    v_cvt_pk_bf16_f32 v83, v98, v99
    v_pk_fma_f32 v[84:85], v[152:153], v[130:131], v[84:85] op_sel:[0,1,0] op_sel_hi:[1,1,1]
    v_pk_fma_f32 v[86:87], v[154:155], v[130:131], v[86:87] op_sel:[0,1,0] op_sel_hi:[1,1,1]
    v_pk_fma_f32 v[100:101], v[156:157], v[130:131], v[100:101] op_sel:[0,1,0] op_sel_hi:[1,1,1]
    v_pk_fma_f32 v[102:103], v[158:159], v[130:131], v[102:103] op_sel:[0,1,0] op_sel_hi:[1,1,1]
    v_permlane32_swap_b32 v80, v82
    v_permlane32_swap_b32 v81, v83
    s_nop 0
    v_permlane16_swap_b32 v80, v82
    v_permlane16_swap_b32 v81, v83
    buffer_store_dwordx4 v[80:83], v5, s[12:15], s66 offen offset:0 sc1
    v_pk_mul_f32 v[84:85], v[84:85], v[130:131] op_sel_hi:[1,0]
    v_pk_mul_f32 v[86:87], v[86:87], v[130:131] op_sel_hi:[1,0]
    v_pk_mul_f32 v[100:101], v[100:101], v[130:131] op_sel_hi:[1,0]
    v_pk_mul_f32 v[102:103], v[102:103], v[130:131] op_sel_hi:[1,0]
    v_pk_mul_f32 v[8:9], v[84:85], s[68:69]
    v_pk_mul_f32 v[10:11], v[86:87], s[68:69]
    v_pk_mul_f32 v[12:13], v[100:101], s[68:69]
    v_pk_mul_f32 v[14:15], v[102:103], s[68:69]
    v_exp_f32 v8, v8
    v_exp_f32 v9, v9
    v_exp_f32 v10, v10
    v_exp_f32 v11, v11
    v_exp_f32 v12, v12
    v_exp_f32 v13, v13
    v_exp_f32 v14, v14
    v_exp_f32 v15, v15
    v_pk_add_f32 v[8:9], v[8:9], 1.0 op_sel_hi:[1,0]
    v_pk_add_f32 v[10:11], v[10:11], 1.0 op_sel_hi:[1,0]
    v_pk_add_f32 v[12:13], v[12:13], 1.0 op_sel_hi:[1,0]
    v_pk_add_f32 v[14:15], v[14:15], 1.0 op_sel_hi:[1,0]
    v_rcp_f32 v8, v8
    v_rcp_f32 v9, v9
    v_rcp_f32 v10, v10
    v_rcp_f32 v11, v11
    v_rcp_f32 v12, v12
    v_rcp_f32 v13, v13
    v_rcp_f32 v14, v14
    v_rcp_f32 v15, v15
    v_pk_mul_f32 v[84:85], v[84:85], v[8:9]
    v_pk_mul_f32 v[86:87], v[86:87], v[10:11]
    v_pk_mul_f32 v[100:101], v[100:101], v[12:13]
    v_pk_mul_f32 v[102:103], v[102:103], v[14:15]
    v_cvt_pk_bf16_f32 v84, v84, v85
    v_cvt_pk_bf16_f32 v85, v86, v87
    v_cvt_pk_bf16_f32 v86, v100, v101
    v_cvt_pk_bf16_f32 v87, v102, v103
    v_pk_fma_f32 v[88:89], v[152:153], v[132:133], v[88:89] op_sel:[0,1,0] op_sel_hi:[1,1,1]
    v_pk_fma_f32 v[90:91], v[154:155], v[132:133], v[90:91] op_sel:[0,1,0] op_sel_hi:[1,1,1]
    v_pk_fma_f32 v[104:105], v[156:157], v[132:133], v[104:105] op_sel:[0,1,0] op_sel_hi:[1,1,1]
    v_pk_fma_f32 v[106:107], v[158:159], v[132:133], v[106:107] op_sel:[0,1,0] op_sel_hi:[1,1,1]
    v_permlane32_swap_b32 v84, v86
    v_permlane32_swap_b32 v85, v87
    s_nop 0
    v_permlane16_swap_b32 v84, v86
    v_permlane16_swap_b32 v85, v87
    buffer_store_dwordx4 v[84:87], v5, s[12:15], s66 offen offset:1024 sc1
    v_pk_mul_f32 v[88:89], v[88:89], v[132:133] op_sel_hi:[1,0]
    v_pk_mul_f32 v[90:91], v[90:91], v[132:133] op_sel_hi:[1,0]
    v_pk_mul_f32 v[104:105], v[104:105], v[132:133] op_sel_hi:[1,0]
    v_pk_mul_f32 v[106:107], v[106:107], v[132:133] op_sel_hi:[1,0]
    v_pk_mul_f32 v[8:9], v[88:89], s[68:69]
    v_pk_mul_f32 v[10:11], v[90:91], s[68:69]
    v_pk_mul_f32 v[12:13], v[104:105], s[68:69]
    v_pk_mul_f32 v[14:15], v[106:107], s[68:69]
    v_exp_f32 v8, v8
    v_exp_f32 v9, v9
    v_exp_f32 v10, v10
    v_exp_f32 v11, v11
    v_exp_f32 v12, v12
    v_exp_f32 v13, v13
    v_exp_f32 v14, v14
    v_exp_f32 v15, v15
    v_pk_add_f32 v[8:9], v[8:9], 1.0 op_sel_hi:[1,0]
    v_pk_add_f32 v[10:11], v[10:11], 1.0 op_sel_hi:[1,0]
    v_pk_add_f32 v[12:13], v[12:13], 1.0 op_sel_hi:[1,0]
    v_pk_add_f32 v[14:15], v[14:15], 1.0 op_sel_hi:[1,0]
    v_rcp_f32 v8, v8
    v_rcp_f32 v9, v9
    v_rcp_f32 v10, v10
    v_rcp_f32 v11, v11
    v_rcp_f32 v12, v12
    v_rcp_f32 v13, v13
    v_rcp_f32 v14, v14
    v_rcp_f32 v15, v15
    v_pk_mul_f32 v[88:89], v[88:89], v[8:9]
    v_pk_mul_f32 v[90:91], v[90:91], v[10:11]
    v_pk_mul_f32 v[104:105], v[104:105], v[12:13]
    v_pk_mul_f32 v[106:107], v[106:107], v[14:15]
    v_cvt_pk_bf16_f32 v88, v88, v89
    v_cvt_pk_bf16_f32 v89, v90, v91
    v_cvt_pk_bf16_f32 v90, v104, v105
    v_cvt_pk_bf16_f32 v91, v106, v107
    v_pk_fma_f32 v[92:93], v[152:153], v[134:135], v[92:93] op_sel:[0,1,0] op_sel_hi:[1,1,1]
    v_pk_fma_f32 v[94:95], v[154:155], v[134:135], v[94:95] op_sel:[0,1,0] op_sel_hi:[1,1,1]
    v_pk_fma_f32 v[108:109], v[156:157], v[134:135], v[108:109] op_sel:[0,1,0] op_sel_hi:[1,1,1]
    v_pk_fma_f32 v[110:111], v[158:159], v[134:135], v[110:111] op_sel:[0,1,0] op_sel_hi:[1,1,1]
    v_permlane32_swap_b32 v88, v90
    v_permlane32_swap_b32 v89, v91
    s_nop 0
    v_permlane16_swap_b32 v88, v90
    v_permlane16_swap_b32 v89, v91
    buffer_store_dwordx4 v[88:91], v6, s[12:15], s66 offen offset:0 sc1
    v_pk_mul_f32 v[92:93], v[92:93], v[134:135] op_sel_hi:[1,0]
    v_pk_mul_f32 v[94:95], v[94:95], v[134:135] op_sel_hi:[1,0]
    v_pk_mul_f32 v[108:109], v[108:109], v[134:135] op_sel_hi:[1,0]
    v_pk_mul_f32 v[110:111], v[110:111], v[134:135] op_sel_hi:[1,0]
    v_pk_mul_f32 v[8:9], v[92:93], s[68:69]
    v_pk_mul_f32 v[10:11], v[94:95], s[68:69]
    v_pk_mul_f32 v[12:13], v[108:109], s[68:69]
    v_pk_mul_f32 v[14:15], v[110:111], s[68:69]
    v_exp_f32 v8, v8
    v_exp_f32 v9, v9
    v_exp_f32 v10, v10
    v_exp_f32 v11, v11
    v_exp_f32 v12, v12
    v_exp_f32 v13, v13
    v_exp_f32 v14, v14
    v_exp_f32 v15, v15
    v_pk_add_f32 v[8:9], v[8:9], 1.0 op_sel_hi:[1,0]
    v_pk_add_f32 v[10:11], v[10:11], 1.0 op_sel_hi:[1,0]
    v_pk_add_f32 v[12:13], v[12:13], 1.0 op_sel_hi:[1,0]
    v_pk_add_f32 v[14:15], v[14:15], 1.0 op_sel_hi:[1,0]
    v_rcp_f32 v8, v8
    v_rcp_f32 v9, v9
    v_rcp_f32 v10, v10
    v_rcp_f32 v11, v11
    v_rcp_f32 v12, v12
    v_rcp_f32 v13, v13
    v_rcp_f32 v14, v14
    v_rcp_f32 v15, v15
    v_pk_mul_f32 v[92:93], v[92:93], v[8:9]
    v_pk_mul_f32 v[94:95], v[94:95], v[10:11]
    v_pk_mul_f32 v[108:109], v[108:109], v[12:13]
    v_pk_mul_f32 v[110:111], v[110:111], v[14:15]
    v_cvt_pk_bf16_f32 v92, v92, v93
    v_cvt_pk_bf16_f32 v93, v94, v95
    v_cvt_pk_bf16_f32 v94, v108, v109
    v_cvt_pk_bf16_f32 v95, v110, v111
    v_pk_fma_f32 v[112:113], v[160:161], v[128:129], v[112:113] op_sel:[0,1,0] op_sel_hi:[1,1,1]
    v_pk_fma_f32 v[114:115], v[162:163], v[128:129], v[114:115] op_sel:[0,1,0] op_sel_hi:[1,1,1]
    v_pk_fma_f32 v[120:121], v[164:165], v[128:129], v[120:121] op_sel:[0,1,0] op_sel_hi:[1,1,1]
    v_pk_fma_f32 v[122:123], v[166:167], v[128:129], v[122:123] op_sel:[0,1,0] op_sel_hi:[1,1,1]
    v_permlane32_swap_b32 v92, v94
    v_permlane32_swap_b32 v93, v95
    s_nop 0
    v_permlane16_swap_b32 v92, v94
    v_permlane16_swap_b32 v93, v95
    buffer_store_dwordx4 v[92:95], v6, s[12:15], s66 offen offset:1024 sc1
    v_pk_mul_f32 v[112:113], v[112:113], v[128:129] op_sel_hi:[1,0]
    v_pk_mul_f32 v[114:115], v[114:115], v[128:129] op_sel_hi:[1,0]
    v_pk_mul_f32 v[120:121], v[120:121], v[128:129] op_sel_hi:[1,0]
    v_pk_mul_f32 v[122:123], v[122:123], v[128:129] op_sel_hi:[1,0]
    v_pk_mul_f32 v[8:9], v[112:113], s[68:69]
    v_pk_mul_f32 v[10:11], v[114:115], s[68:69]
    v_pk_mul_f32 v[12:13], v[120:121], s[68:69]
    v_pk_mul_f32 v[14:15], v[122:123], s[68:69]
    v_exp_f32 v8, v8
    v_exp_f32 v9, v9
    v_exp_f32 v10, v10
    v_exp_f32 v11, v11
    v_exp_f32 v12, v12
    v_exp_f32 v13, v13
    v_exp_f32 v14, v14
    v_exp_f32 v15, v15
    v_pk_add_f32 v[8:9], v[8:9], 1.0 op_sel_hi:[1,0]
    v_pk_add_f32 v[10:11], v[10:11], 1.0 op_sel_hi:[1,0]
    v_pk_add_f32 v[12:13], v[12:13], 1.0 op_sel_hi:[1,0]
    v_pk_add_f32 v[14:15], v[14:15], 1.0 op_sel_hi:[1,0]
    v_rcp_f32 v8, v8
    v_rcp_f32 v9, v9
    v_rcp_f32 v10, v10
    v_rcp_f32 v11, v11
    v_rcp_f32 v12, v12
    v_rcp_f32 v13, v13
    v_rcp_f32 v14, v14
    v_rcp_f32 v15, v15
    v_pk_mul_f32 v[112:113], v[112:113], v[8:9]
    v_pk_mul_f32 v[114:115], v[114:115], v[10:11]
    v_pk_mul_f32 v[120:121], v[120:121], v[12:13]
    v_pk_mul_f32 v[122:123], v[122:123], v[14:15]
    v_cvt_pk_bf16_f32 v112, v112, v113
    v_cvt_pk_bf16_f32 v113, v114, v115
    v_cvt_pk_bf16_f32 v114, v120, v121
    v_cvt_pk_bf16_f32 v115, v122, v123
    v_pk_fma_f32 v[116:117], v[160:161], v[130:131], v[116:117] op_sel:[0,1,0] op_sel_hi:[1,1,1]
    v_pk_fma_f32 v[118:119], v[162:163], v[130:131], v[118:119] op_sel:[0,1,0] op_sel_hi:[1,1,1]
    v_pk_fma_f32 v[124:125], v[164:165], v[130:131], v[124:125] op_sel:[0,1,0] op_sel_hi:[1,1,1]
    v_pk_fma_f32 v[126:127], v[166:167], v[130:131], v[126:127] op_sel:[0,1,0] op_sel_hi:[1,1,1]
    v_permlane32_swap_b32 v112, v114
    v_permlane32_swap_b32 v113, v115
    s_nop 0
    v_permlane16_swap_b32 v112, v114
    v_permlane16_swap_b32 v113, v115
    buffer_store_dwordx4 v[112:115], v5, s[12:15], s67 offen offset:0 sc1
    v_pk_mul_f32 v[116:117], v[116:117], v[130:131] op_sel_hi:[1,0]
    v_pk_mul_f32 v[118:119], v[118:119], v[130:131] op_sel_hi:[1,0]
    v_pk_mul_f32 v[124:125], v[124:125], v[130:131] op_sel_hi:[1,0]
    v_pk_mul_f32 v[126:127], v[126:127], v[130:131] op_sel_hi:[1,0]
    v_pk_mul_f32 v[8:9], v[116:117], s[68:69]
    v_pk_mul_f32 v[10:11], v[118:119], s[68:69]
    v_pk_mul_f32 v[12:13], v[124:125], s[68:69]
    v_pk_mul_f32 v[14:15], v[126:127], s[68:69]
    v_exp_f32 v8, v8
    v_exp_f32 v9, v9
    v_exp_f32 v10, v10
    v_exp_f32 v11, v11
    v_exp_f32 v12, v12
    v_exp_f32 v13, v13
    v_exp_f32 v14, v14
    v_exp_f32 v15, v15
    v_pk_add_f32 v[8:9], v[8:9], 1.0 op_sel_hi:[1,0]
    v_pk_add_f32 v[10:11], v[10:11], 1.0 op_sel_hi:[1,0]
    v_pk_add_f32 v[12:13], v[12:13], 1.0 op_sel_hi:[1,0]
    v_pk_add_f32 v[14:15], v[14:15], 1.0 op_sel_hi:[1,0]
    v_rcp_f32 v8, v8
    v_rcp_f32 v9, v9
    v_rcp_f32 v10, v10
    v_rcp_f32 v11, v11
    v_rcp_f32 v12, v12
    v_rcp_f32 v13, v13
    v_rcp_f32 v14, v14
    v_rcp_f32 v15, v15
    v_pk_mul_f32 v[116:117], v[116:117], v[8:9]
    v_pk_mul_f32 v[118:119], v[118:119], v[10:11]
    v_pk_mul_f32 v[124:125], v[124:125], v[12:13]
    v_pk_mul_f32 v[126:127], v[126:127], v[14:15]
    v_cvt_pk_bf16_f32 v116, v116, v117
    v_cvt_pk_bf16_f32 v117, v118, v119
    v_cvt_pk_bf16_f32 v118, v124, v125
    v_cvt_pk_bf16_f32 v119, v126, v127
    s_nop 1
    v_permlane32_swap_b32 v116, v118
    v_permlane32_swap_b32 v117, v119
    s_nop 0
    v_permlane16_swap_b32 v116, v118
    v_permlane16_swap_b32 v117, v119
    buffer_store_dwordx4 v[116:119], v5, s[12:15], s67 offen offset:1024 sc1
p4_c:
    s_and_b32 s34, s2, 7
    s_lshr_b32 s35, s2, 3
    s_lshr_b32 s39, s35, 3
    s_and_b32 s54, s35, 7
    s_and_b32 s3, s34, 1
    s_lshr_b32 s25, s34, 1
    s_lshl2_add_u32 s25, s25, s39
    s_mov_b32 s26, s54
    s_lshr_b32 s27, s24, 1
    s_and_b32 s28, s24, 1
    v_and_b32 v16, 15, v1
    v_lshrrev_b32 v17, 4, v1
    v_bfe_u32 v18, v16, 1, 3
    v_xor_b32 v18, v18, v17
    v_lshlrev_b32 v18, 4, v18
    v_lshl_add_u32 v19, v16, 7, v18
    s_lshl_b32 s34, s27, 1
    s_add_u32 s34, s34, s3
    s_lshl_b32 s34, s34, 12
    v_add_u32 v2, s34, v19
    v_xor_b32 v3, 64, v2
    s_lshl_b32 s34, s27, 1
    s_add_u32 s34, s34, s3
    s_lshl_b32 s34, s34, 12
    s_xor_b32 s34, s34, 4096
    v_add_u32 v4, s34, v19
    v_xor_b32 v5, 64, v4
    v_bfe_u32 v18, v1, 2, 2
    v_lshl_add_u32 v18, v17, 3, v18
    v_bfe_u32 v19, v1, 1, 1
    v_and_b32 v20, 1, v1
    v_lshlrev_b32 v20, 3, v20
    v_bfe_u32 v21, v1, 3, 2
    v_lshlrev_b32 v21, 1, v21
    v_xor_b32 v21, v21, v19
    v_lshl_add_u32 v21, v21, 4, v20
    v_lshl_add_u32 v21, v18, 7, v21
    v_xor_b32 v6, 0, v21
    s_mul_i32 s34, s28, 8192
    s_add_u32 s34, s34, 16384
    v_add_u32 v6, s34, v6
    v_xor_b32 v7, 32, v21
    s_mul_i32 s34, s28, 8192
    s_add_u32 s34, s34, 16384
    v_add_u32 v7, s34, v7
    v_xor_b32 v8, 64, v21
    s_mul_i32 s34, s28, 8192
    s_add_u32 s34, s34, 16384
    v_add_u32 v8, s34, v8
    v_xor_b32 v9, 96, v21
    s_mul_i32 s34, s28, 8192
    s_add_u32 s34, s34, 16384
    v_add_u32 v9, s34, v9
    s_mov_b32 s12, s88
    s_mov_b32 s13, s89
    s_mov_b32 s14, 0x400000
    s_mov_b32 s15, 0x20000
    v_and_b32 v80, 15, v1
    v_lshrrev_b32 v81, 4, v1
    s_lshl_b32 s35, s27, 1
    s_add_u32 s35, s35, s3
    s_lshl_b32 s35, s35, 12
    s_lshl_b32 s34, s25, 14
    s_add_u32 s34, s34, s35
    s_lshl_b32 s34, s34, 4
    s_lshl_b32 s35, s26, 1
    s_add_u32 s35, s35, s28
    s_lshl_b32 s35, s35, 7
    s_add_u32 s64, s34, s35
    v_lshrrev_b32 v85, 3, v1
    v_lshlrev_b32 v85, 11, v85
    v_and_b32 v82, 7, v1
    v_lshl_add_u32 v85, v82, 4, v85
    s_add_u32 s65, s64, 16384
    s_add_u32 s66, s64, 32768
    s_add_u32 s67, s64, 49152
    v_and_b32 v82, 7, v80
    v_lshlrev_b32 v82, 11, v82
    v_lshl_add_u32 v84, v81, 4, v82
    v_lshrrev_b32 v82, 3, v80
    v_lshl_add_u32 v84, v82, 6, v84
    v_bfe_u32 v82, v80, 1, 3
    v_lshrrev_b32 v83, 1, v81
    v_xor_b32 v82, v82, v83
    v_lshlrev_b32 v82, 4, v82
    v_and_b32 v83, 1, v81
    v_lshl_add_u32 v82, v83, 3, v82
    v_lshl_add_u32 v82, v80, 7, v82
    s_lshl_b32 s34, s24, 12
    s_add_u32 s34, s34, 131072
    v_xor_b32 v124, 0, v82
    v_add_u32 v124, s34, v124
    v_xor_b32 v125, 32, v82
    v_add_u32 v125, s34, v125
    v_xor_b32 v126, 64, v82
    v_add_u32 v126, s34, v126
    v_xor_b32 v127, 96, v82
    v_add_u32 v127, s34, v127
    v_mov_b64 v[16:17], 0
    v_mov_b64 v[18:19], 0
    v_mov_b64 v[20:21], 0
    v_mov_b64 v[22:23], 0
    v_mov_b64 v[24:25], 0
    v_mov_b64 v[26:27], 0
    v_mov_b64 v[28:29], 0
    v_mov_b64 v[30:31], 0
    v_mov_b64 v[32:33], 0
    v_mov_b64 v[34:35], 0
    v_mov_b64 v[36:37], 0
    v_mov_b64 v[38:39], 0
    v_mov_b64 v[40:41], 0
    v_mov_b64 v[42:43], 0
    v_mov_b64 v[44:45], 0
    v_mov_b64 v[46:47], 0
    v_mov_b64 v[48:49], 0
    v_mov_b64 v[50:51], 0
    v_mov_b64 v[52:53], 0
    v_mov_b64 v[54:55], 0
    v_mov_b64 v[56:57], 0
    v_mov_b64 v[58:59], 0
    v_mov_b64 v[60:61], 0
    v_mov_b64 v[62:63], 0
    v_mov_b64 v[64:65], 0
    v_mov_b64 v[66:67], 0
    v_mov_b64 v[68:69], 0
    v_mov_b64 v[70:71], 0
    v_mov_b64 v[72:73], 0
    v_mov_b64 v[74:75], 0
    v_mov_b64 v[76:77], 0
    v_mov_b64 v[78:79], 0
    s_mov_b32 s32, 0
    s_mov_b32 s36, 32768
    s_mov_b32 s37, 4294868992
    s_setprio 3
    s_waitcnt vmcnt(0)
    s_barrier
    s_barrier
    s_barrier
    ds_read_b128 a[0:3], v2 offset:0
    ds_read_b128 a[4:7], v2 offset:2048
    ds_read_b128 a[8:11], v4 offset:0
    ds_read_b128 a[12:15], v4 offset:2048
    ds_read_b64_tr_b16 a[16:17], v6 offset:0
    ds_read_b64_tr_b16 a[18:19], v6 offset:512
    ds_read_b64_tr_b16 a[20:21], v7 offset:0
    ds_read_b64_tr_b16 a[22:23], v7 offset:512
    ds_read_b64_tr_b16 a[24:25], v8 offset:0
    ds_read_b64_tr_b16 a[26:27], v8 offset:512
    ds_read_b64_tr_b16 a[28:29], v9 offset:0
    ds_read_b64_tr_b16 a[30:31], v9 offset:512
    s_mov_b32 s31, 28
Lc_9:
    s_waitcnt lgkmcnt(0)
    v_mfma_f32_16x16x32_bf16 v[16:19], a[16:19], a[0:3], v[16:19]
    ds_read_b128 a[32:35], v3 offset:0
    v_mfma_f32_16x16x32_bf16 v[20:23], a[16:19], a[4:7], v[20:23]
    ds_read_b128 a[36:39], v3 offset:2048
    v_mfma_f32_16x16x32_bf16 v[24:27], a[16:19], a[8:11], v[24:27]
    ds_read_b128 a[40:43], v5 offset:0
    v_mfma_f32_16x16x32_bf16 v[28:31], a[16:19], a[12:15], v[28:31]
    ds_read_b128 a[44:47], v5 offset:2048
    v_mfma_f32_16x16x32_bf16 v[32:35], a[20:23], a[0:3], v[32:35]
    ds_read_b64_tr_b16 a[48:49], v6 offset:4096
    v_mfma_f32_16x16x32_bf16 v[36:39], a[20:23], a[4:7], v[36:39]
    ds_read_b64_tr_b16 a[50:51], v6 offset:4608
    v_mfma_f32_16x16x32_bf16 v[40:43], a[20:23], a[8:11], v[40:43]
    ds_read_b64_tr_b16 a[52:53], v7 offset:4096
    v_mfma_f32_16x16x32_bf16 v[44:47], a[20:23], a[12:15], v[44:47]
    ds_read_b64_tr_b16 a[54:55], v7 offset:4608
    v_mfma_f32_16x16x32_bf16 v[48:51], a[24:27], a[0:3], v[48:51]
    ds_read_b64_tr_b16 a[56:57], v8 offset:4096
    v_mfma_f32_16x16x32_bf16 v[52:55], a[24:27], a[4:7], v[52:55]
    ds_read_b64_tr_b16 a[58:59], v8 offset:4608
    v_mfma_f32_16x16x32_bf16 v[56:59], a[24:27], a[8:11], v[56:59]
    ds_read_b64_tr_b16 a[60:61], v9 offset:4096
    v_mfma_f32_16x16x32_bf16 v[60:63], a[24:27], a[12:15], v[60:63]
    ds_read_b64_tr_b16 a[62:63], v9 offset:4608
    v_mfma_f32_16x16x32_bf16 v[64:67], a[28:31], a[0:3], v[64:67]
    s_add_u32 s32, s32, 32768
    s_cmp_eq_u32 s32, 131072
    v_mfma_f32_16x16x32_bf16 v[68:71], a[28:31], a[4:7], v[68:71]
    s_cselect_b32 s33, s37, s36
    s_cselect_b32 s32, 0, s32
    v_mfma_f32_16x16x32_bf16 v[72:75], a[28:31], a[8:11], v[72:75]
    v_add_u32 v2, s33, v2
    v_add_u32 v4, s33, v4
    v_mfma_f32_16x16x32_bf16 v[76:79], a[28:31], a[12:15], v[76:79]
    v_add_u32 v6, s33, v6
    v_add_u32 v7, s33, v7
    v_add_u32 v8, s33, v8
    v_add_u32 v9, s33, v9
    s_waitcnt lgkmcnt(0)
    s_barrier
    v_mfma_f32_16x16x32_bf16 v[16:19], a[48:51], a[32:35], v[16:19]
    ds_read_b128 a[0:3], v2 offset:0
    v_mfma_f32_16x16x32_bf16 v[20:23], a[48:51], a[36:39], v[20:23]
    ds_read_b128 a[4:7], v2 offset:2048
    v_mfma_f32_16x16x32_bf16 v[24:27], a[48:51], a[40:43], v[24:27]
    ds_read_b128 a[8:11], v4 offset:0
    v_mfma_f32_16x16x32_bf16 v[28:31], a[48:51], a[44:47], v[28:31]
    ds_read_b128 a[12:15], v4 offset:2048
    v_mfma_f32_16x16x32_bf16 v[32:35], a[52:55], a[32:35], v[32:35]
    ds_read_b64_tr_b16 a[16:17], v6 offset:0
    v_mfma_f32_16x16x32_bf16 v[36:39], a[52:55], a[36:39], v[36:39]
    ds_read_b64_tr_b16 a[18:19], v6 offset:512
    v_mfma_f32_16x16x32_bf16 v[40:43], a[52:55], a[40:43], v[40:43]
    ds_read_b64_tr_b16 a[20:21], v7 offset:0
    v_mfma_f32_16x16x32_bf16 v[44:47], a[52:55], a[44:47], v[44:47]
    ds_read_b64_tr_b16 a[22:23], v7 offset:512
    v_mfma_f32_16x16x32_bf16 v[48:51], a[56:59], a[32:35], v[48:51]
    ds_read_b64_tr_b16 a[24:25], v8 offset:0
    v_mfma_f32_16x16x32_bf16 v[52:55], a[56:59], a[36:39], v[52:55]
    ds_read_b64_tr_b16 a[26:27], v8 offset:512
    v_mfma_f32_16x16x32_bf16 v[56:59], a[56:59], a[40:43], v[56:59]
    ds_read_b64_tr_b16 a[28:29], v9 offset:0
    v_mfma_f32_16x16x32_bf16 v[60:63], a[56:59], a[44:47], v[60:63]
    ds_read_b64_tr_b16 a[30:31], v9 offset:512
    v_mfma_f32_16x16x32_bf16 v[64:67], a[60:63], a[32:35], v[64:67]
    v_add_u32 v3, s33, v3
    v_mfma_f32_16x16x32_bf16 v[68:71], a[60:63], a[36:39], v[68:71]
    v_add_u32 v5, s33, v5
    v_mfma_f32_16x16x32_bf16 v[72:75], a[60:63], a[40:43], v[72:75]
    s_sub_u32 s31, s31, 1
    v_mfma_f32_16x16x32_bf16 v[76:79], a[60:63], a[44:47], v[76:79]
    s_cmp_lg_u32 s31, 0
    s_cbranch_scc1 Lc_9
    s_waitcnt lgkmcnt(0)
    s_setprio 0
    s_nop 7
p4_epi:
    ds_read_b64 v[128:129], v124 offset:0
    ds_read_b64 v[130:131], v125 offset:0
    ds_read_b64 v[132:133], v126 offset:0
    ds_read_b64 v[134:135], v127 offset:0
    ds_read_b64 v[136:137], v124 offset:2048
    ds_read_b64 v[138:139], v125 offset:2048
    ds_read_b64 v[140:141], v126 offset:2048
    ds_read_b64 v[142:143], v127 offset:2048
    v_cvt_pk_bf16_f32 v24, v24, v25
    v_cvt_pk_bf16_f32 v25, v26, v27
    v_cvt_pk_bf16_f32 v26, v40, v41
    v_cvt_pk_bf16_f32 v27, v42, v43
    v_min_u32 v24, -2, v24
    v_min_u32 v25, -2, v25
    v_min_u32 v26, -2, v26
    v_min_u32 v27, -2, v27
    s_xor_b32 s34, s64, 65536
    buffer_store_dwordx4 v[24:27], v85, s[12:15], s34 offen sc1
    v_cvt_pk_bf16_f32 v56, v56, v57
    v_cvt_pk_bf16_f32 v57, v58, v59
    v_cvt_pk_bf16_f32 v58, v72, v73
    v_cvt_pk_bf16_f32 v59, v74, v75
    v_min_u32 v56, -2, v56
    v_min_u32 v57, -2, v57
    v_min_u32 v58, -2, v58
    v_min_u32 v59, -2, v59
    s_xor_b32 s34, s65, 65536
    buffer_store_dwordx4 v[56:59], v85, s[12:15], s34 offen sc1
    v_cvt_pk_bf16_f32 v28, v28, v29
    v_cvt_pk_bf16_f32 v29, v30, v31
    v_cvt_pk_bf16_f32 v30, v44, v45
    v_cvt_pk_bf16_f32 v31, v46, v47
    v_min_u32 v28, -2, v28
    v_min_u32 v29, -2, v29
    v_min_u32 v30, -2, v30
    v_min_u32 v31, -2, v31
    s_xor_b32 s34, s66, 65536
    buffer_store_dwordx4 v[28:31], v85, s[12:15], s34 offen sc1
    v_cvt_pk_bf16_f32 v60, v60, v61
    v_cvt_pk_bf16_f32 v61, v62, v63
    v_cvt_pk_bf16_f32 v62, v76, v77
    v_cvt_pk_bf16_f32 v63, v78, v79
    v_min_u32 v60, -2, v60
    v_min_u32 v61, -2, v61
    v_min_u32 v62, -2, v62
    v_min_u32 v63, -2, v63
    s_xor_b32 s34, s67, 65536
    buffer_store_dwordx4 v[60:63], v85, s[12:15], s34 offen sc1
    s_waitcnt lgkmcnt(0)
    v_lshlrev_b32 v86, 16, v128
    v_and_b32 v87, 0xffff0000, v128
    v_lshlrev_b32 v88, 16, v129
    v_and_b32 v89, 0xffff0000, v129
    v_pk_add_f32 v[16:17], v[16:17], v[86:87]
    v_pk_add_f32 v[18:19], v[18:19], v[88:89]
    v_lshlrev_b32 v90, 16, v130
    v_and_b32 v91, 0xffff0000, v130
    v_lshlrev_b32 v92, 16, v131
    v_and_b32 v93, 0xffff0000, v131
    v_pk_add_f32 v[32:33], v[32:33], v[90:91]
    v_pk_add_f32 v[34:35], v[34:35], v[92:93]
    v_lshlrev_b32 v86, 16, v132
    v_and_b32 v87, 0xffff0000, v132
    v_lshlrev_b32 v88, 16, v133
    v_and_b32 v89, 0xffff0000, v133
    v_pk_add_f32 v[48:49], v[48:49], v[86:87]
    v_pk_add_f32 v[50:51], v[50:51], v[88:89]
    v_lshlrev_b32 v90, 16, v134
    v_and_b32 v91, 0xffff0000, v134
    v_lshlrev_b32 v92, 16, v135
    v_and_b32 v93, 0xffff0000, v135
    v_pk_add_f32 v[64:65], v[64:65], v[90:91]
    v_pk_add_f32 v[66:67], v[66:67], v[92:93]
    v_lshlrev_b32 v86, 16, v136
    v_and_b32 v87, 0xffff0000, v136
    v_lshlrev_b32 v88, 16, v137
    v_and_b32 v89, 0xffff0000, v137
    v_pk_add_f32 v[20:21], v[20:21], v[86:87]
    v_pk_add_f32 v[22:23], v[22:23], v[88:89]
    v_lshlrev_b32 v90, 16, v138
    v_and_b32 v91, 0xffff0000, v138
    v_lshlrev_b32 v92, 16, v139
    v_and_b32 v93, 0xffff0000, v139
    v_pk_add_f32 v[36:37], v[36:37], v[90:91]
    v_pk_add_f32 v[38:39], v[38:39], v[92:93]
    v_lshlrev_b32 v86, 16, v140
    v_and_b32 v87, 0xffff0000, v140
    v_lshlrev_b32 v88, 16, v141
    v_and_b32 v89, 0xffff0000, v141
    v_pk_add_f32 v[52:53], v[52:53], v[86:87]
    v_pk_add_f32 v[54:55], v[54:55], v[88:89]
    v_lshlrev_b32 v90, 16, v142
    v_and_b32 v91, 0xffff0000, v142
    v_lshlrev_b32 v92, 16, v143
    v_and_b32 v93, 0xffff0000, v143
    v_pk_add_f32 v[68:69], v[68:69], v[90:91]
    v_pk_add_f32 v[70:71], v[70:71], v[92:93]
    s_mov_b32 s63, 262144
Lxp_10:
    buffer_load_dwordx4 v[128:131], v85, s[12:15], s64 offen sc1
    buffer_load_dwordx4 v[132:135], v85, s[12:15], s65 offen sc1
    buffer_load_dwordx4 v[136:139], v85, s[12:15], s66 offen sc1
    buffer_load_dwordx4 v[140:143], v85, s[12:15], s67 offen sc1
    s_sub_u32 s63, s63, 1
    s_cbranch_scc1 Lxe_11
    s_waitcnt vmcnt(0)
    v_max3_u32 v86, v128, v129, v130
    v_max3_u32 v86, v86, v131, v132
    v_max3_u32 v86, v86, v133, v134
    v_max3_u32 v86, v86, v135, v136
    v_max3_u32 v86, v86, v137, v138
    v_max3_u32 v86, v86, v139, v140
    v_max3_u32 v86, v86, v141, v142
    v_max_u32 v86, v86, v143
    v_cmp_eq_u32 vcc, -1, v86
    s_cbranch_vccnz Lxp_10
Lxe_11:
    v_lshlrev_b32 v86, 16, v128
    v_and_b32 v87, 0xffff0000, v128
    v_lshlrev_b32 v88, 16, v129
    v_and_b32 v89, 0xffff0000, v129
    v_pk_add_f32 v[16:17], v[16:17], v[86:87]
    v_pk_add_f32 v[18:19], v[18:19], v[88:89]
    v_lshlrev_b32 v90, 16, v130
    v_and_b32 v91, 0xffff0000, v130
    v_lshlrev_b32 v92, 16, v131
    v_and_b32 v93, 0xffff0000, v131
    v_pk_add_f32 v[32:33], v[32:33], v[90:91]
    v_pk_add_f32 v[34:35], v[34:35], v[92:93]
    v_lshlrev_b32 v86, 16, v132
    v_and_b32 v87, 0xffff0000, v132
    v_lshlrev_b32 v88, 16, v133
    v_and_b32 v89, 0xffff0000, v133
    v_pk_add_f32 v[48:49], v[48:49], v[86:87]
    v_pk_add_f32 v[50:51], v[50:51], v[88:89]
    v_lshlrev_b32 v90, 16, v134
    v_and_b32 v91, 0xffff0000, v134
    v_lshlrev_b32 v92, 16, v135
    v_and_b32 v93, 0xffff0000, v135
    v_pk_add_f32 v[64:65], v[64:65], v[90:91]
    v_pk_add_f32 v[66:67], v[66:67], v[92:93]
    v_cvt_pk_bf16_f32 v96, v16, v17
    v_cvt_pk_bf16_f32 v97, v18, v19
    v_cvt_pk_bf16_f32 v98, v32, v33
    v_cvt_pk_bf16_f32 v99, v34, v35
    v_cvt_pk_bf16_f32 v100, v48, v49
    v_cvt_pk_bf16_f32 v101, v50, v51
    v_cvt_pk_bf16_f32 v102, v64, v65
    v_cvt_pk_bf16_f32 v103, v66, v67
    s_nop 1
    v_permlane32_swap_b32 v96, v98
    v_permlane32_swap_b32 v97, v99
    s_nop 0
    v_permlane16_swap_b32 v96, v98
    v_permlane16_swap_b32 v97, v99
    v_permlane32_swap_b32 v100, v102
    v_permlane32_swap_b32 v101, v103
    s_nop 0
    v_permlane16_swap_b32 v100, v102
    v_permlane16_swap_b32 v101, v103
    v_mov_b32 v120, v96
    v_mov_b32 v121, v97
    v_mov_b32 v122, v98
    v_mov_b32 v123, v99
    v_mov_b32_dpp v96, v100 row_ror:8 row_mask:0xf bank_mask:0xc
    v_mov_b32_dpp v97, v101 row_ror:8 row_mask:0xf bank_mask:0xc
    v_mov_b32_dpp v98, v102 row_ror:8 row_mask:0xf bank_mask:0xc
    v_mov_b32_dpp v99, v103 row_ror:8 row_mask:0xf bank_mask:0xc
    v_mov_b32_dpp v100, v120 row_ror:8 row_mask:0xf bank_mask:0x3
    v_mov_b32_dpp v101, v121 row_ror:8 row_mask:0xf bank_mask:0x3
    v_mov_b32_dpp v102, v122 row_ror:8 row_mask:0xf bank_mask:0x3
    v_mov_b32_dpp v103, v123 row_ror:8 row_mask:0xf bank_mask:0x3
    buffer_store_dwordx4 v[96:99], v84, s[12:15], s64 offen sc1
    buffer_store_dwordx4 v[100:103], v84, s[12:15], s65 offen sc1
    v_lshlrev_b32 v86, 16, v136
    v_and_b32 v87, 0xffff0000, v136
    v_lshlrev_b32 v88, 16, v137
    v_and_b32 v89, 0xffff0000, v137
    v_pk_add_f32 v[20:21], v[20:21], v[86:87]
    v_pk_add_f32 v[22:23], v[22:23], v[88:89]
    v_lshlrev_b32 v90, 16, v138
    v_and_b32 v91, 0xffff0000, v138
    v_lshlrev_b32 v92, 16, v139
    v_and_b32 v93, 0xffff0000, v139
    v_pk_add_f32 v[36:37], v[36:37], v[90:91]
    v_pk_add_f32 v[38:39], v[38:39], v[92:93]
    v_lshlrev_b32 v86, 16, v140
    v_and_b32 v87, 0xffff0000, v140
    v_lshlrev_b32 v88, 16, v141
    v_and_b32 v89, 0xffff0000, v141
    v_pk_add_f32 v[52:53], v[52:53], v[86:87]
    v_pk_add_f32 v[54:55], v[54:55], v[88:89]
    v_lshlrev_b32 v90, 16, v142
    v_and_b32 v91, 0xffff0000, v142
    v_lshlrev_b32 v92, 16, v143
    v_and_b32 v93, 0xffff0000, v143
    v_pk_add_f32 v[68:69], v[68:69], v[90:91]
    v_pk_add_f32 v[70:71], v[70:71], v[92:93]
    v_cvt_pk_bf16_f32 v104, v20, v21
    v_cvt_pk_bf16_f32 v105, v22, v23
    v_cvt_pk_bf16_f32 v106, v36, v37
    v_cvt_pk_bf16_f32 v107, v38, v39
    v_cvt_pk_bf16_f32 v108, v52, v53
    v_cvt_pk_bf16_f32 v109, v54, v55
    v_cvt_pk_bf16_f32 v110, v68, v69
    v_cvt_pk_bf16_f32 v111, v70, v71
    s_nop 1
    v_permlane32_swap_b32 v104, v106
    v_permlane32_swap_b32 v105, v107
    s_nop 0
    v_permlane16_swap_b32 v104, v106
    v_permlane16_swap_b32 v105, v107
    v_permlane32_swap_b32 v108, v110
    v_permlane32_swap_b32 v109, v111
    s_nop 0
    v_permlane16_swap_b32 v108, v110
    v_permlane16_swap_b32 v109, v111
    v_mov_b32 v120, v104
    v_mov_b32 v121, v105
    v_mov_b32 v122, v106
    v_mov_b32 v123, v107
    v_mov_b32_dpp v104, v108 row_ror:8 row_mask:0xf bank_mask:0xc
    v_mov_b32_dpp v105, v109 row_ror:8 row_mask:0xf bank_mask:0xc
    v_mov_b32_dpp v106, v110 row_ror:8 row_mask:0xf bank_mask:0xc
    v_mov_b32_dpp v107, v111 row_ror:8 row_mask:0xf bank_mask:0xc
    v_mov_b32_dpp v108, v120 row_ror:8 row_mask:0xf bank_mask:0x3
    v_mov_b32_dpp v109, v121 row_ror:8 row_mask:0xf bank_mask:0x3
    v_mov_b32_dpp v110, v122 row_ror:8 row_mask:0xf bank_mask:0x3
    v_mov_b32_dpp v111, v123 row_ror:8 row_mask:0xf bank_mask:0x3
    buffer_store_dwordx4 v[104:107], v84, s[12:15], s66 offen sc1
    buffer_store_dwordx4 v[108:111], v84, s[12:15], s67 offen sc1
    s_endpgm
Lha_4:
    s_mov_b32 s72, s78
    s_mov_b32 s73, s79
    s_mov_b32 s74, 0x600000
    s_mov_b32 s75, 0x20000
    s_lshr_b32 s41, s2, 3
    s_lshl_b32 s41, s41, 2
    s_add_u32 s41, s41, s24
    s_mul_i32 s41, s41, 49152
    s_and_b32 s40, s2, 2
    s_lshl_b32 s40, s40, 9
    s_add_u32 s41, s41, s40
    s_add_u32 s41, s41, 384
    s_bitcmp1_b32 s2, 0
    s_cselect_b32 s41, 0x1000000, s41
    v_min_u32 v8, 23, v1
    v_lshlrev_b32 v8, 11, v8
    buffer_load_dword v167, v8, s[72:75], s41 offen
    s_waitcnt vmcnt(1)
    v_lshlrev_b32 v144, 16, v128
    v_and_b32 v145, 0xffff0000, v128
    v_mov_b64 v[8:9], v[144:145]
    v_pk_mul_f32 v[10:11], v[144:145], v[144:145]
    v_lshlrev_b32 v146, 16, v136
    v_and_b32 v147, 0xffff0000, v136
    v_mov_b64 v[12:13], v[146:147]
    v_pk_mul_f32 v[14:15], v[146:147], v[146:147]
    v_lshlrev_b32 v144, 16, v129
    v_and_b32 v145, 0xffff0000, v129
    v_pk_add_f32 v[8:9], v[8:9], v[144:145]
    v_pk_fma_f32 v[10:11], v[144:145], v[144:145], v[10:11]
    v_lshlrev_b32 v146, 16, v137
    v_and_b32 v147, 0xffff0000, v137
    v_pk_add_f32 v[12:13], v[12:13], v[146:147]
    v_pk_fma_f32 v[14:15], v[146:147], v[146:147], v[14:15]
    v_lshlrev_b32 v144, 16, v130
    v_and_b32 v145, 0xffff0000, v130
    v_pk_add_f32 v[8:9], v[8:9], v[144:145]
    v_pk_fma_f32 v[10:11], v[144:145], v[144:145], v[10:11]
    v_lshlrev_b32 v146, 16, v138
    v_and_b32 v147, 0xffff0000, v138
    v_pk_add_f32 v[12:13], v[12:13], v[146:147]
    v_pk_fma_f32 v[14:15], v[146:147], v[146:147], v[14:15]
    v_lshlrev_b32 v144, 16, v131
    v_and_b32 v145, 0xffff0000, v131
    v_pk_add_f32 v[8:9], v[8:9], v[144:145]
    v_pk_fma_f32 v[10:11], v[144:145], v[144:145], v[10:11]
    v_lshlrev_b32 v146, 16, v139
    v_and_b32 v147, 0xffff0000, v139
    v_pk_add_f32 v[12:13], v[12:13], v[146:147]
    v_pk_fma_f32 v[14:15], v[146:147], v[146:147], v[14:15]
    v_lshlrev_b32 v144, 16, v132
    v_and_b32 v145, 0xffff0000, v132
    v_pk_add_f32 v[8:9], v[8:9], v[144:145]
    v_pk_fma_f32 v[10:11], v[144:145], v[144:145], v[10:11]
    v_lshlrev_b32 v146, 16, v140
    v_and_b32 v147, 0xffff0000, v140
    v_pk_add_f32 v[12:13], v[12:13], v[146:147]
    v_pk_fma_f32 v[14:15], v[146:147], v[146:147], v[14:15]
    v_lshlrev_b32 v144, 16, v133
    v_and_b32 v145, 0xffff0000, v133
    v_pk_add_f32 v[8:9], v[8:9], v[144:145]
    v_pk_fma_f32 v[10:11], v[144:145], v[144:145], v[10:11]
    v_lshlrev_b32 v146, 16, v141
    v_and_b32 v147, 0xffff0000, v141
    v_pk_add_f32 v[12:13], v[12:13], v[146:147]
    v_pk_fma_f32 v[14:15], v[146:147], v[146:147], v[14:15]
    v_lshlrev_b32 v144, 16, v134
    v_and_b32 v145, 0xffff0000, v134
    v_pk_add_f32 v[8:9], v[8:9], v[144:145]
    v_pk_fma_f32 v[10:11], v[144:145], v[144:145], v[10:11]
    v_lshlrev_b32 v146, 16, v142
    v_and_b32 v147, 0xffff0000, v142
    v_pk_add_f32 v[12:13], v[12:13], v[146:147]
    v_pk_fma_f32 v[14:15], v[146:147], v[146:147], v[14:15]
    v_lshlrev_b32 v144, 16, v135
    v_and_b32 v145, 0xffff0000, v135
    v_pk_add_f32 v[8:9], v[8:9], v[144:145]
    v_pk_fma_f32 v[10:11], v[144:145], v[144:145], v[10:11]
    v_lshlrev_b32 v146, 16, v143
    v_and_b32 v147, 0xffff0000, v143
    v_pk_add_f32 v[12:13], v[12:13], v[146:147]
    v_pk_fma_f32 v[14:15], v[146:147], v[146:147], v[14:15]
    v_add_f32 v8, v8, v9
    v_add_f32 v12, v12, v13
    v_add_f32 v10, v10, v11
    v_add_f32 v14, v14, v15
    s_add_u32 s16, s92, 0x1d00000
    s_addc_u32 s17, s93, 0
    s_mov_b32 s18, 0x4000
    s_mov_b32 s19, 0x20000
    v_permlane32_swap_b32 v8, v12
    v_permlane32_swap_b32 v10, v14
    s_nop 0
    v_add_f32 v8, v8, v12
    v_add_f32 v9, v10, v14
    s_nop 0
    v_mov_b32 v10, v8
    v_mov_b32 v11, v9
    s_nop 1
    v_permlane16_swap_b32 v8, v10
    v_permlane16_swap_b32 v9, v11
    s_nop 0
    v_add_f32 v8, v8, v10
    v_add_f32 v9, v9, v11
    s_nop 1
    v_add_f32_dpp v8, v8, v8 row_ror:1 row_mask:0xf bank_mask:0xf
    v_add_f32_dpp v9, v9, v9 row_ror:1 row_mask:0xf bank_mask:0xf
    s_nop 1
    v_add_f32_dpp v8, v8, v8 row_ror:2 row_mask:0xf bank_mask:0xf
    v_add_f32_dpp v9, v9, v9 row_ror:2 row_mask:0xf bank_mask:0xf
    s_nop 1
    v_add_f32_dpp v8, v8, v8 row_ror:4 row_mask:0xf bank_mask:0xf
    v_add_f32_dpp v9, v9, v9 row_ror:4 row_mask:0xf bank_mask:0xf
    s_nop 1
    v_add_f32_dpp v8, v8, v8 row_ror:8 row_mask:0xf bank_mask:0xf
    v_add_f32_dpp v9, v9, v9 row_ror:8 row_mask:0xf bank_mask:0xf
    v_mul_f32 v8, 0x3a800000, v8
    v_mul_f32 v9, 0x3a800000, v9
    v_fma_f32 v9, -v8, v8, v9
    v_max_f32 v9, 0, v9
    v_cvt_pk_bf16_f32 v10, v8, v9
    v_lshlrev_b32 v11, 16, v10
    v_and_b32 v9, 0xffff0000, v10
    v_add_f32 v9, 0x3727c5ac, v9
    v_cvt_pk_bf16_f32 v10, v9, v9
    v_and_b32 v9, 0xffff0000, v10
    v_sqrt_f32 v9, v9
    s_nop 0
    v_cvt_pk_bf16_f32 v10, v9, v9
    v_and_b32 v9, 0xffff0000, v10
    v_rcp_f32 v8, v9
    v_sub_f32 v9, 0, v11
    v_lshrrev_b32 v10, 5, v1
    v_lshlrev_b32 v10, 3, v10
    s_mov_b32 exec_lo, 1
    s_mov_b32 exec_hi, 1
    buffer_store_dwordx2 v[8:9], v10, s[16:19], s42 offen sc1
    s_add_u32 s72, s92, 0x2000000
    s_addc_u32 s73, s93, 0
    s_mov_b32 s74, 0x4000
    s_mov_b32 s75, 0x20000
    s_mov_b64 exec, 15
    v_mov_b32 v12, 0
    v_lshlrev_b32 v13, 2, v1
    buffer_store_dword v12, v13, s[72:75], s42 offen sc1
    s_mov_b64 exec, -1
    s_nop 3
    s_branch Lhb_5
Lfg_2:
    s_waitcnt vmcnt(0)
    s_branch Lfb_3
sequential_preLN__sliding_local_dilated__dense_activation_silu__prompt_kernel_loader:
    s_sub_u32 s55, s24, 4
    v_lshrrev_b32 v2, 3, v1
    v_and_b32 v3, 7, v1
    v_lshrrev_b32 v4, 4, v1
p1_l:
    v_xor_b32 v5, v4, v3
    v_mul_u32_u24 v6, 2048, v2
    v_lshl_add_u32 v8, v5, 4, v6
    v_xor_b32 v9, 64, v8
    v_add_u32 v9, 15360, v9
    v_add_u32 v10, 30720, v8
    v_add_u32 v11, 30720, v9
    s_lshl_b32 s34, s25, 2
    s_add_u32 s34, s34, s55
    s_mul_i32 s29, s34, 65536
    s_lshl_b32 s35, s55, 1
    v_add_u32 v5, s35, v4
    v_xor_b32 v5, v5, v3
    v_and_b32 v5, 7, v5
    v_lshl_add_u32 v12, v5, 4, v6
    s_lshl_b32 s34, s25, 5
    s_add_u32 s34, s34, s55
    s_sub_i32 s34, s34, 4
    s_max_i32 s34, s34, 0
    s_mul_i32 s38, s34, 8192
    v_and_b32 v5, 1, v4
    v_lshlrev_b32 v5, 1, v5
    v_xor_b32 v5, v5, v3
    v_mul_u32_u24 v6, 6144, v2
    v_lshl_add_u32 v6, v5, 4, v6
    v_xor_b32 v7, 64, v6
    v_add_u32 v7, 48128, v7
    v_add_u32 v13, 2048, v6
    v_add_u32 v14, 2048, v7
    v_add_u32 v15, 4096, v6
    v_add_u32 v16, 4096, v7
    s_mul_i32 s30, s55, 98304
    s_mul_i32 s34, s26, 128
    s_add_u32 s30, s30, s34
    s_mul_i32 s64, s55, 4096
    s_add_u32 s64, s64, 2048
    s_mul_i32 s65, s55, 512
    s_mul_i32 s66, s55, 2048
    s_add_u32 s66, s66, 18432
    s_mul_i32 s67, s55, 2048
    s_add_u32 s67, s67, 26624
    s_mul_i32 s68, s55, 2048
    s_add_u32 s68, s68, 34816
    s_mov_b32 s40, s29
    s_mov_b32 s41, s30
    s_mov_b32 s42, s38
    s_cmp_eq_u32 s55, 0
    s_cselect_b32 s27, 0xffffff00, -1
    s_add_u32 s43, s39, s54
    s_and_b32 s43, s43, 3
    s_mov_b32 s100, 0x40808035
    s_mov_b32 s101, 0x0
    s_cmp_eq_u32 s43, 1
    s_cselect_b32 s100, 0x20200d5, s100
    s_cselect_b32 s101, 0x0, s101
    s_cmp_eq_u32 s43, 2
    s_cselect_b32 s100, 0x54080355, s100
    s_cselect_b32 s101, 0x0, s101
    s_cmp_eq_u32 s43, 3
    s_cselect_b32 s100, 0x50200d55, s100
    s_cselect_b32 s101, 0x0, s101
    s_waitcnt lgkmcnt(0)
    s_setprio 2
    s_mov_b32 s4, s76
    s_mov_b32 s5, s77
    s_mov_b32 s6, 0x400000
    s_mov_b32 s7, 0x20000
    s_mov_b32 s8, s78
    s_mov_b32 s9, s79
    s_mov_b32 s10, 0x600000
    s_mov_b32 s11, 0x20000
    s_mov_b32 s32, 0
    s_mov_b32 s94, 0
    s_and_b32 s95, s100, 1
    s_and_b32 s96, s100, 2
    s_lshl1_add_u32 s95, s96, s95
    s_add_u32 s95, s95, s94
    s_sub_u32 s95, s95, 1
    s_lshr_b64 s[100:101], s[100:101], 2
    s_mul_i32 s96, s95, 393216
    s_mul_i32 s95, s95, 128
    s_add_u32 s29, s40, s95
    s_add_u32 s30, s41, s96
    s_add_u32 s38, s42, s95
    s_add_u32 s94, s94, 1
    s_add_u32 m0, s32, s64
    s_nop 0
    buffer_load_dwordx4 v8, s[4:7], s29 offen offset:0  lds
    buffer_load_dwordx4 v9, s[4:7], s29 offen offset:1024  lds
    buffer_load_dwordx4 v10, s[4:7], s29 offen offset:2048  lds
    buffer_load_dwordx4 v11, s[4:7], s29 offen offset:3072  lds
    s_add_u32 m0, s32, s65
    s_mov_b32 exec_hi, 0
    s_mov_b32 exec_lo, s27
    buffer_load_dwordx4 v12, s[4:7], s38 offen offset:0  lds
    s_mov_b64 exec, -1
    s_add_u32 m0, s32, s66
    s_nop 0
    buffer_load_dwordx4 v6, s[8:11], s30 offen offset:0  lds
    buffer_load_dwordx4 v7, s[8:11], s30 offen offset:1024  lds
    s_add_u32 m0, s32, s67
    s_nop 0
    buffer_load_dwordx4 v13, s[8:11], s30 offen offset:0  lds
    buffer_load_dwordx4 v14, s[8:11], s30 offen offset:1024  lds
    s_add_u32 m0, s32, s68
    s_nop 0
    buffer_load_dwordx4 v15, s[8:11], s30 offen offset:0  lds
    buffer_load_dwordx4 v16, s[8:11], s30 offen offset:1024  lds
    s_add_u32 s32, s32, 43008
    s_cmp_eq_u32 s32, 129024
    s_cselect_b32 s32, 0, s32
    s_and_b32 s95, s100, 1
    s_and_b32 s96, s100, 2
    s_lshl1_add_u32 s95, s96, s95
    s_add_u32 s95, s95, s94
    s_sub_u32 s95, s95, 1
    s_lshr_b64 s[100:101], s[100:101], 2
    s_mul_i32 s96, s95, 393216
    s_mul_i32 s95, s95, 128
    s_add_u32 s29, s40, s95
    s_add_u32 s30, s41, s96
    s_add_u32 s38, s42, s95
    s_add_u32 s94, s94, 1
    s_add_u32 m0, s32, s64
    s_nop 0
    buffer_load_dwordx4 v8, s[4:7], s29 offen offset:0  lds
    buffer_load_dwordx4 v9, s[4:7], s29 offen offset:1024  lds
    buffer_load_dwordx4 v10, s[4:7], s29 offen offset:2048  lds
    buffer_load_dwordx4 v11, s[4:7], s29 offen offset:3072  lds
    s_add_u32 m0, s32, s65
    s_mov_b32 exec_hi, 0
    s_mov_b32 exec_lo, s27
    buffer_load_dwordx4 v12, s[4:7], s38 offen offset:0  lds
    s_mov_b64 exec, -1
    s_add_u32 m0, s32, s66
    s_nop 0
    buffer_load_dwordx4 v6, s[8:11], s30 offen offset:0  lds
    s_add_u32 s16, s92, 0x1d00000
    s_addc_u32 s17, s93, 0
    s_mov_b32 s18, 0x4000
    s_mov_b32 s19, 0x20000
    v_mov_b32 v46, 0x3f803f80
    v_and_b32 v47, 31, v1
    v_lshlrev_b32 v47, 2, v47
    ds_write_b32 v47, v46
    ds_write_b32 v47, v46 offset:43008
    v_add_u32 v47, 86016, v47
    ds_write_b32 v47, v46
    s_waitcnt lgkmcnt(0)
    s_waitcnt vmcnt(6)
    s_barrier
    buffer_load_dwordx4 v7, s[8:11], s30 offen offset:1024  lds
    s_add_u32 m0, s32, s67
    s_nop 0
    buffer_load_dwordx4 v13, s[8:11], s30 offen offset:0  lds
    buffer_load_dwordx4 v14, s[8:11], s30 offen offset:1024  lds
    s_add_u32 m0, s32, s68
    s_nop 0
    buffer_load_dwordx4 v15, s[8:11], s30 offen offset:0  lds
    buffer_load_dwordx4 v16, s[8:11], s30 offen offset:1024  lds
    s_add_u32 s32, s32, 43008
    s_cmp_eq_u32 s32, 129024
    s_cselect_b32 s32, 0, s32
    s_and_b32 s95, s100, 1
    s_and_b32 s96, s100, 2
    s_lshl1_add_u32 s95, s96, s95
    s_add_u32 s95, s95, s94
    s_sub_u32 s95, s95, 1
    s_lshr_b64 s[100:101], s[100:101], 2
    s_mul_i32 s96, s95, 393216
    s_mul_i32 s95, s95, 128
    s_add_u32 s29, s40, s95
    s_add_u32 s30, s41, s96
    s_add_u32 s38, s42, s95
    s_add_u32 s94, s94, 1
    s_add_u32 m0, s32, s64
    s_nop 0
    buffer_load_dwordx4 v8, s[4:7], s29 offen offset:0  lds
    buffer_load_dwordx4 v9, s[4:7], s29 offen offset:1024  lds
    buffer_load_dwordx4 v10, s[4:7], s29 offen offset:2048  lds
    buffer_load_dwordx4 v11, s[4:7], s29 offen offset:3072  lds
    s_add_u32 m0, s32, s65
    s_mov_b32 exec_hi, 0
    s_mov_b32 exec_lo, s27
    buffer_load_dwordx4 v12, s[4:7], s38 offen offset:0  lds
    s_mov_b64 exec, -1
    s_add_u32 m0, s32, s66
    s_nop 0
    buffer_load_dwordx4 v6, s[8:11], s30 offen offset:0  lds
    buffer_load_dwordx4 v7, s[8:11], s30 offen offset:1024  lds
    s_add_u32 m0, s32, s67
    s_waitcnt vmcnt(7)
    s_barrier
    buffer_load_dwordx4 v13, s[8:11], s30 offen offset:0  lds
    buffer_load_dwordx4 v14, s[8:11], s30 offen offset:1024  lds
    s_add_u32 m0, s32, s68
    s_nop 0
    buffer_load_dwordx4 v15, s[8:11], s30 offen offset:0  lds
    buffer_load_dwordx4 v16, s[8:11], s30 offen offset:1024  lds
    s_add_u32 s32, s32, 43008
    s_cmp_eq_u32 s32, 129024
    s_cselect_b32 s32, 0, s32
    s_and_b32 s95, s100, 1
    s_and_b32 s96, s100, 2
    s_lshl1_add_u32 s95, s96, s95
    s_add_u32 s95, s95, s94
    s_sub_u32 s95, s95, 1
    s_lshr_b64 s[100:101], s[100:101], 2
    s_mul_i32 s96, s95, 393216
    s_mul_i32 s95, s95, 128
    s_add_u32 s29, s40, s95
    s_add_u32 s30, s41, s96
    s_add_u32 s38, s42, s95
    s_add_u32 s94, s94, 1
    s_add_u32 m0, s32, s64
    s_nop 0
    buffer_load_dwordx4 v8, s[4:7], s29 offen offset:0  lds
    buffer_load_dwordx4 v9, s[4:7], s29 offen offset:1024  lds
    buffer_load_dwordx4 v10, s[4:7], s29 offen offset:2048  lds
    buffer_load_dwordx4 v11, s[4:7], s29 offen offset:3072  lds
    s_add_u32 m0, s32, s65
    s_mov_b32 exec_hi, 0
    s_mov_b32 exec_lo, s27
    buffer_load_dwordx4 v12, s[4:7], s38 offen offset:0  lds
    s_mov_b64 exec, -1
    s_add_u32 m0, s32, s66
    s_nop 0
    buffer_load_dwordx4 v6, s[8:11], s30 offen offset:0  lds
    buffer_load_dwordx4 v7, s[8:11], s30 offen offset:1024  lds
    s_add_u32 m0, s32, s67
    s_nop 0
    buffer_load_dwordx4 v13, s[8:11], s30 offen offset:0  lds
    s_waitcnt vmcnt(8)
    s_barrier
    buffer_load_dwordx4 v14, s[8:11], s30 offen offset:1024  lds
    s_add_u32 m0, s32, s68
    s_nop 0
    buffer_load_dwordx4 v15, s[8:11], s30 offen offset:0  lds
    buffer_load_dwordx4 v16, s[8:11], s30 offen offset:1024  lds
    s_add_u32 s32, s32, 43008
    s_cmp_eq_u32 s32, 129024
    s_cselect_b32 s32, 0, s32
    s_and_b32 s95, s100, 1
    s_and_b32 s96, s100, 2
    s_lshl1_add_u32 s95, s96, s95
    s_add_u32 s95, s95, s94
    s_sub_u32 s95, s95, 1
    s_lshr_b64 s[100:101], s[100:101], 2
    s_mul_i32 s96, s95, 393216
    s_mul_i32 s95, s95, 128
    s_add_u32 s29, s40, s95
    s_add_u32 s30, s41, s96
    s_add_u32 s38, s42, s95
    s_add_u32 s94, s94, 1
    s_add_u32 m0, s32, s64
    s_nop 0
    buffer_load_dwordx4 v8, s[4:7], s29 offen offset:0  lds
    buffer_load_dwordx4 v9, s[4:7], s29 offen offset:1024  lds
    buffer_load_dwordx4 v10, s[4:7], s29 offen offset:2048  lds
    buffer_load_dwordx4 v11, s[4:7], s29 offen offset:3072  lds
    s_add_u32 m0, s32, s65
    s_mov_b32 exec_hi, 0
    s_mov_b32 exec_lo, s27
    buffer_load_dwordx4 v12, s[4:7], s38 offen offset:0  lds
    s_mov_b64 exec, -1
    s_add_u32 m0, s32, s66
    s_nop 0
    buffer_load_dwordx4 v6, s[8:11], s30 offen offset:0  lds
    buffer_load_dwordx4 v7, s[8:11], s30 offen offset:1024  lds
    s_add_u32 m0, s32, s67
    s_nop 0
    buffer_load_dwordx4 v13, s[8:11], s30 offen offset:0  lds
    buffer_load_dwordx4 v14, s[8:11], s30 offen offset:1024  lds
    s_add_u32 m0, s32, s68
    s_waitcnt vmcnt(9)
    s_barrier
    buffer_load_dwordx4 v15, s[8:11], s30 offen offset:0  lds
    buffer_load_dwordx4 v16, s[8:11], s30 offen offset:1024  lds
    s_add_u32 s32, s32, 43008
    s_cmp_eq_u32 s32, 129024
    s_cselect_b32 s32, 0, s32
    s_and_b32 s95, s100, 1
    s_and_b32 s96, s100, 2
    s_lshl1_add_u32 s95, s96, s95
    s_add_u32 s95, s95, s94
    s_sub_u32 s95, s95, 1
    s_lshr_b64 s[100:101], s[100:101], 2
    s_mul_i32 s96, s95, 393216
    s_mul_i32 s95, s95, 128
    s_add_u32 s29, s40, s95
    s_add_u32 s30, s41, s96
    s_add_u32 s38, s42, s95
    s_add_u32 s94, s94, 1
    s_add_u32 m0, s32, s64
    s_nop 0
    buffer_load_dwordx4 v8, s[4:7], s29 offen offset:0  lds
    buffer_load_dwordx4 v9, s[4:7], s29 offen offset:1024  lds
    buffer_load_dwordx4 v10, s[4:7], s29 offen offset:2048  lds
    buffer_load_dwordx4 v11, s[4:7], s29 offen offset:3072  lds
    s_add_u32 m0, s32, s65
    s_mov_b32 exec_hi, 0
    s_mov_b32 exec_lo, s27
    buffer_load_dwordx4 v12, s[4:7], s38 offen offset:0  lds
    s_mov_b64 exec, -1
    s_add_u32 m0, s32, s66
    s_nop 0
    buffer_load_dwordx4 v6, s[8:11], s30 offen offset:0  lds
    buffer_load_dwordx4 v7, s[8:11], s30 offen offset:1024  lds
    s_add_u32 m0, s32, s67
    s_nop 0
    buffer_load_dwordx4 v13, s[8:11], s30 offen offset:0  lds
    buffer_load_dwordx4 v14, s[8:11], s30 offen offset:1024  lds
    s_add_u32 m0, s32, s68
    s_nop 0
    buffer_load_dwordx4 v15, s[8:11], s30 offen offset:0  lds
    buffer_load_dwordx4 v16, s[8:11], s30 offen offset:1024  lds
    s_add_u32 s32, s32, 43008
    s_cmp_eq_u32 s32, 129024
    s_cselect_b32 s32, 0, s32
    s_and_b32 s95, s100, 1
    s_and_b32 s96, s100, 2
    s_lshl1_add_u32 s95, s96, s95
    s_add_u32 s95, s95, s94
    s_sub_u32 s95, s95, 1
    s_lshr_b64 s[100:101], s[100:101], 2
    s_mul_i32 s96, s95, 393216
    s_mul_i32 s95, s95, 128
    s_add_u32 s29, s40, s95
    s_add_u32 s30, s41, s96
    s_add_u32 s38, s42, s95
    s_add_u32 s94, s94, 1
    s_add_u32 m0, s32, s64
    s_waitcnt vmcnt(11)
    s_barrier
    buffer_load_dwordx4 v8, s[4:7], s29 offen offset:0  lds
    buffer_load_dwordx4 v9, s[4:7], s29 offen offset:1024  lds
    buffer_load_dwordx4 v10, s[4:7], s29 offen offset:2048  lds
    buffer_load_dwordx4 v11, s[4:7], s29 offen offset:3072  lds
    s_add_u32 m0, s32, s65
    s_mov_b32 exec_hi, 0
    s_mov_b32 exec_lo, s27
    buffer_load_dwordx4 v12, s[4:7], s38 offen offset:0  lds
    s_mov_b64 exec, -1
    s_add_u32 m0, s32, s66
    s_nop 0
    buffer_load_dwordx4 v6, s[8:11], s30 offen offset:0  lds
    buffer_load_dwordx4 v7, s[8:11], s30 offen offset:1024  lds
    s_add_u32 m0, s32, s67
    s_nop 0
    buffer_load_dwordx4 v13, s[8:11], s30 offen offset:0  lds
    buffer_load_dwordx4 v14, s[8:11], s30 offen offset:1024  lds
    s_add_u32 m0, s32, s68
    s_nop 0
    buffer_load_dwordx4 v15, s[8:11], s30 offen offset:0  lds
    buffer_load_dwordx4 v16, s[8:11], s30 offen offset:1024  lds
    s_add_u32 s32, s32, 43008
    s_cmp_eq_u32 s32, 129024
    s_cselect_b32 s32, 0, s32
    s_and_b32 s95, s100, 1
    s_and_b32 s96, s100, 2
    s_lshl1_add_u32 s95, s96, s95
    s_add_u32 s95, s95, s94
    s_sub_u32 s95, s95, 1
    s_lshr_b64 s[100:101], s[100:101], 2
    s_mul_i32 s96, s95, 393216
    s_mul_i32 s95, s95, 128
    s_add_u32 s29, s40, s95
    s_add_u32 s30, s41, s96
    s_add_u32 s38, s42, s95
    s_add_u32 s94, s94, 1
    s_add_u32 m0, s32, s64
    s_waitcnt vmcnt(11)
    s_barrier
    buffer_load_dwordx4 v8, s[4:7], s29 offen offset:0  lds
    buffer_load_dwordx4 v9, s[4:7], s29 offen offset:1024  lds
    buffer_load_dwordx4 v10, s[4:7], s29 offen offset:2048  lds
    buffer_load_dwordx4 v11, s[4:7], s29 offen offset:3072  lds
    s_add_u32 m0, s32, s65
    s_mov_b32 exec_hi, 0
    s_mov_b32 exec_lo, s27
    buffer_load_dwordx4 v12, s[4:7], s38 offen offset:0  lds
    s_mov_b64 exec, -1
    s_add_u32 m0, s32, s66
    s_nop 0
    buffer_load_dwordx4 v6, s[8:11], s30 offen offset:0  lds
    buffer_load_dwordx4 v7, s[8:11], s30 offen offset:1024  lds
    s_add_u32 m0, s32, s67
    s_nop 0
    buffer_load_dwordx4 v13, s[8:11], s30 offen offset:0  lds
    buffer_load_dwordx4 v14, s[8:11], s30 offen offset:1024  lds
    s_add_u32 m0, s32, s68
    s_nop 0
    buffer_load_dwordx4 v15, s[8:11], s30 offen offset:0  lds
    buffer_load_dwordx4 v16, s[8:11], s30 offen offset:1024  lds
    s_add_u32 s32, s32, 43008
    s_cmp_eq_u32 s32, 129024
    s_cselect_b32 s32, 0, s32
    s_and_b32 s95, s100, 1
    s_and_b32 s96, s100, 2
    s_lshl1_add_u32 s95, s96, s95
    s_add_u32 s95, s95, s94
    s_sub_u32 s95, s95, 1
    s_lshr_b64 s[100:101], s[100:101], 2
    s_mul_i32 s96, s95, 393216
    s_mul_i32 s95, s95, 128
    s_add_u32 s29, s40, s95
    s_add_u32 s30, s41, s96
    s_add_u32 s38, s42, s95
    s_add_u32 s94, s94, 1
    s_add_u32 m0, s32, s64
    s_cmp_lg_u32 s55, 0
    s_cbranch_scc1 Lc1f_12
    s_mov_b32 s34, 1
    s_atomic_add s34, s[90:91], 0
Lc1f_12:
    s_mov_b32 s31, 6
Lld_13:
    s_waitcnt vmcnt(11)
    s_barrier
    buffer_load_dwordx4 v8, s[4:7], s29 offen offset:0  lds
    buffer_load_dwordx4 v9, s[4:7], s29 offen offset:1024  lds
    buffer_load_dwordx4 v10, s[4:7], s29 offen offset:2048  lds
    buffer_load_dwordx4 v11, s[4:7], s29 offen offset:3072  lds
    s_add_u32 m0, s32, s65
    s_mov_b32 exec_hi, 0
    s_mov_b32 exec_lo, s27
    buffer_load_dwordx4 v12, s[4:7], s38 offen offset:0  lds
    s_mov_b64 exec, -1
    s_add_u32 m0, s32, s66
    s_nop 0
    buffer_load_dwordx4 v6, s[8:11], s30 offen offset:0  lds
    buffer_load_dwordx4 v7, s[8:11], s30 offen offset:1024  lds
    s_add_u32 m0, s32, s67
    s_nop 0
    buffer_load_dwordx4 v13, s[8:11], s30 offen offset:0  lds
    buffer_load_dwordx4 v14, s[8:11], s30 offen offset:1024  lds
    s_add_u32 m0, s32, s68
    s_nop 0
    buffer_load_dwordx4 v15, s[8:11], s30 offen offset:0  lds
    buffer_load_dwordx4 v16, s[8:11], s30 offen offset:1024  lds
    s_add_u32 s32, s32, 43008
    s_cmp_eq_u32 s32, 129024
    s_cselect_b32 s32, 0, s32
    s_and_b32 s95, s100, 1
    s_and_b32 s96, s100, 2
    s_lshl1_add_u32 s95, s96, s95
    s_add_u32 s95, s95, s94
    s_sub_u32 s95, s95, 1
    s_lshr_b64 s[100:101], s[100:101], 2
    s_mul_i32 s96, s95, 393216
    s_mul_i32 s95, s95, 128
    s_add_u32 s29, s40, s95
    s_add_u32 s30, s41, s96
    s_add_u32 s38, s42, s95
    s_add_u32 s94, s94, 1
    s_add_u32 m0, s32, s64
    s_sub_u32 s31, s31, 1
    s_cmp_lg_u32 s31, 0
    s_cbranch_scc1 Lld_13
    s_waitcnt vmcnt(11)
    s_barrier
    s_mov_b32 s72, s90
    s_mov_b32 s73, s91
    s_mov_b32 s74, 0x100
    s_mov_b32 s75, 0x20000
    v_mov_b32 v46, 0
    buffer_load_dword v44, v46, s[72:75], 0 offen sc1
    buffer_load_dwordx4 v8, s[4:7], s29 offen offset:0  lds
    buffer_load_dwordx4 v9, s[4:7], s29 offen offset:1024  lds
    buffer_load_dwordx4 v10, s[4:7], s29 offen offset:2048  lds
    buffer_load_dwordx4 v11, s[4:7], s29 offen offset:3072  lds
    s_add_u32 m0, s32, s65
    s_mov_b32 exec_hi, 0
    s_mov_b32 exec_lo, s27
    buffer_load_dwordx4 v12, s[4:7], s38 offen offset:0  lds
    s_mov_b64 exec, -1
    s_add_u32 m0, s32, s66
    s_nop 0
    buffer_load_dwordx4 v6, s[8:11], s30 offen offset:0  lds
    buffer_load_dwordx4 v7, s[8:11], s30 offen offset:1024  lds
    s_add_u32 m0, s32, s67
    s_nop 0
    buffer_load_dwordx4 v13, s[8:11], s30 offen offset:0  lds
    buffer_load_dwordx4 v14, s[8:11], s30 offen offset:1024  lds
    s_add_u32 m0, s32, s68
    s_nop 0
    buffer_load_dwordx4 v15, s[8:11], s30 offen offset:0  lds
    buffer_load_dwordx4 v16, s[8:11], s30 offen offset:1024  lds
    s_add_u32 s32, s32, 43008
    s_cmp_eq_u32 s32, 129024
    s_cselect_b32 s32, 0, s32
    s_and_b32 s95, s100, 1
    s_and_b32 s96, s100, 2
    s_lshl1_add_u32 s95, s96, s95
    s_add_u32 s95, s95, s94
    s_sub_u32 s95, s95, 1
    s_lshr_b64 s[100:101], s[100:101], 2
    s_mul_i32 s96, s95, 393216
    s_mul_i32 s95, s95, 128
    s_add_u32 s29, s40, s95
    s_add_u32 s30, s41, s96
    s_add_u32 s38, s42, s95
    s_add_u32 s94, s94, 1
    s_add_u32 m0, s32, s64
    s_waitcnt vmcnt(12)
    s_barrier
    buffer_load_dwordx4 v8, s[4:7], s29 offen offset:0  lds
    v_bfe_u32 v64, v1, 4, 1
    v_lshlrev_b32 v64, 3, v64
    v_bfe_u32 v65, v1, 5, 1
    v_lshl_add_u32 v64, v65, 2, v64
    buffer_load_dwordx4 v9, s[4:7], s29 offen offset:1024  lds
    v_bfe_u32 v65, v1, 2, 2
    v_add_u32 v64, v64, v65
    v_bfe_u32 v65, v1, 3, 2
    v_lshlrev_b32 v65, 1, v65
    buffer_load_dwordx4 v10, s[4:7], s29 offen offset:2048  lds
    v_bfe_u32 v66, v1, 1, 1
    v_xor_b32 v65, v65, v66
    v_and_b32 v66, 1, v1
    v_lshlrev_b32 v66, 3, v66
    buffer_load_dwordx4 v11, s[4:7], s29 offen offset:3072  lds
    v_lshl_add_u32 v65, v65, 4, v66
    v_lshl_add_u32 v24, v64, 7, v65
    s_mul_i32 s34, s55, 36
    v_add_u32 v33, s34, v1
    s_add_u32 m0, s32, s65
    s_mov_b32 exec_hi, 0
    s_mov_b32 exec_lo, s27
    buffer_load_dwordx4 v12, s[4:7], s38 offen offset:0  lds
    s_mov_b64 exec, -1
    s_lshl_b32 s35, s25, 7
    s_sub_i32 s35, s35, 16
    v_add_u32 v34, s35, v33
    v_max_i32 v34, 0, v34
    s_add_u32 m0, s32, s66
    s_nop 0
    buffer_load_dwordx4 v6, s[8:11], s30 offen offset:0  lds
    v_lshlrev_b32 v34, 3, v34
    v_lshlrev_b32 v33, 2, v33
    v_add_u32 v33, 129024, v33
    buffer_load_dwordx4 v7, s[8:11], s30 offen offset:1024  lds
    s_xor_b32 s34, s2, 1
    s_lshl_b32 s34, s34, 2
    s_add_u32 s34, s34, s55
    s_add_u32 m0, s32, s67
    s_nop 0
    buffer_load_dwordx4 v13, s[8:11], s30 offen offset:0  lds
    s_mul_hi_u32 s46, s34, 76695845
    s_mul_i32 s35, s46, 56
    s_sub_u32 s47, s34, s35
    buffer_load_dwordx4 v14, s[8:11], s30 offen offset:1024  lds
    s_mul_i32 s44, s46, 458752
    s_lshl_b32 s35, s47, 7
    s_add_u32 s44, s44, s35
    s_add_u32 m0, s32, s68
    s_nop 0
    buffer_load_dwordx4 v15, s[8:11], s30 offen offset:0  lds
    v_and_b32 v96, 1, v4
    v_lshlrev_b32 v96, 1, v96
    v_xor_b32 v96, v96, v3
    buffer_load_dwordx4 v16, s[8:11], s30 offen offset:1024  lds
    s_add_u32 s32, s32, 43008
    s_cmp_eq_u32 s32, 129024
    s_cselect_b32 s32, 0, s32
    s_and_b32 s95, s100, 1
    s_and_b32 s96, s100, 2
    s_lshl1_add_u32 s95, s96, s95
    s_add_u32 s95, s95, s94
    s_sub_u32 s95, s95, 1
    s_lshr_b64 s[100:101], s[100:101], 2
    s_mul_i32 s96, s95, 393216
    s_mul_i32 s95, s95, 128
    s_add_u32 s29, s40, s95
    s_add_u32 s30, s41, s96
    s_add_u32 s38, s42, s95
    s_add_u32 s94, s94, 1
    v_mul_u32_u24 v97, 7168, v2
    v_lshl_add_u32 v96, v96, 4, v97
    v_xor_b32 v97, 64, v96
    s_add_u32 m0, s32, s64
    s_waitcnt vmcnt(11)
    s_barrier
    s_mov_b32 s63, 262144
Lpo_14:
    v_cmp_gt_u32 vcc, 0x100, v44
    s_cbranch_vccz Lpd_15
    s_sub_u32 s63, s63, 1
    s_cbranch_scc1 Lpd_15
    s_sleep 4
    buffer_load_dword v44, v46, s[72:75], 0 offen sc1
    s_waitcnt vmcnt(0)
    s_branch Lpo_14
Lpd_15:
    buffer_load_dwordx2 v[36:37], v34, s[16:19], 0 offen sc1
    s_mov_b32 s8, s84
    s_mov_b32 s9, s85
    s_mov_b32 s10, 0x700000
    s_mov_b32 s11, 0x20000
    s_lshl_b32 s35, s55, 13
    s_add_u32 s35, s35, 131072
    s_mov_b32 m0, s35
    s_add_u32 s35, s35, 1024
    buffer_load_dwordx4 v96, s[8:11], s44 offen lds
    s_add_u32 s44, s44, 57344
    s_mov_b32 m0, s35
    s_add_u32 s35, s35, 1024
    buffer_load_dwordx4 v97, s[8:11], s44 offen lds
    s_add_u32 s44, s44, 57344
    s_mov_b32 m0, s35
    s_add_u32 s35, s35, 1024
    buffer_load_dwordx4 v96, s[8:11], s44 offen lds
    s_add_u32 s44, s44, 57344
    s_mov_b32 m0, s35
    s_add_u32 s35, s35, 1024
    buffer_load_dwordx4 v97, s[8:11], s44 offen lds
    s_add_u32 s44, s44, 57344
    s_mov_b32 m0, s35
    s_add_u32 s35, s35, 1024
    buffer_load_dwordx4 v96, s[8:11], s44 offen lds
    s_add_u32 s44, s44, 57344
    s_mov_b32 m0, s35
    s_add_u32 s35, s35, 1024
    buffer_load_dwordx4 v97, s[8:11], s44 offen lds
    s_add_u32 s44, s44, 57344
    s_mov_b32 m0, s35
    s_add_u32 s35, s35, 1024
    buffer_load_dwordx4 v96, s[8:11], s44 offen lds
    s_add_u32 s44, s44, 57344
    s_mov_b32 m0, s35
    s_add_u32 s35, s35, 1024
    buffer_load_dwordx4 v97, s[8:11], s44 offen lds
    s_mov_b32 s72, s80
    s_mov_b32 s73, s81
    s_mov_b32 s74, 0x200000
    s_mov_b32 s75, 0x20000
    s_lshl_b32 s34, s2, 2
    s_add_u32 s34, s34, s55
    s_mul_i32 s34, s34, 2048
    v_min_u32 v98, 15, v1
    v_lshlrev_b32 v98, 7, v98
    buffer_load_dword v99, v98, s[72:75], s34 offen
    s_waitcnt vmcnt(10)
    s_barrier
    s_waitcnt vmcnt(9)
    s_mov_b32 exec_hi, 15
    ds_write_b32 v33, v36 offset:0
    ds_write_b32 v33, v37 offset:576
    s_mov_b32 exec_hi, -1
    s_waitcnt lgkmcnt(0)
    s_barrier
p2_l:
    s_lshl_b32 s28, s25, 8
    s_lshl_b32 s34, s26, 4
    s_add_u32 s28, s28, s34
    s_add_u32 s28, s28, 0
    s_and_b32 s34, s2, 7
    s_lshr_b32 s35, s2, 3
    s_lshr_b32 s39, s35, 3
    s_and_b32 s54, s35, 7
    s_lshr_b32 s36, s34, 1
    s_and_b32 s37, s34, 1
    s_lshl_b32 s25, s36, 2
    s_lshl_b32 s26, s37, 3
    s_add_u32 s25, s25, s39
    s_add_u32 s26, s26, s54
    v_xor_b32 v5, v4, v3
    v_lshrrev_b32 v8, 2, v5
    v_lshlrev_b32 v8, 13, v8
    v_and_b32 v5, 3, v5
    v_lshl_add_u32 v8, v5, 4, v8
    v_lshl_add_u32 v8, v2, 6, v8
    v_xor_b32 v9, 0x2000, v8
    v_add_u32 v9, 3584, v9
    v_add_u32 v10, 3072, v8
    v_add_u32 v11, -1024, v9
    v_add_u32 v8, 4096, v8
    s_mul_i32 s29, s25, 262144
    s_lshl_b32 s34, s55, 11
    s_add_u32 s29, s29, s34
    v_and_b32 v5, 1, v4
    v_lshlrev_b32 v5, 1, v5
    v_xor_b32 v5, v5, v3
    v_mul_u32_u24 v6, 2048, v2
    v_lshl_add_u32 v6, v5, 4, v6
    v_xor_b32 v7, 64, v6
    v_add_u32 v7, 15360, v7
    s_mul_i32 s30, s55, 32768
    s_mul_i32 s34, s26, 128
    s_add_u32 s30, s30, s34
    s_mul_i32 s64, s55, 4096
    s_add_u32 s64, s64, 98304
    s_mul_i32 s65, s55, 2048
    s_mov_b32 s40, s29
    s_mov_b32 s41, s30
    s_add_u32 s43, s39, s54
    s_and_b32 s43, s43, 3
    s_mov_b32 s100, 0x40808035
    s_mov_b32 s101, 0x0
    s_cmp_eq_u32 s43, 1
    s_cselect_b32 s100, 0x20200d5, s100
    s_cselect_b32 s101, 0x0, s101
    s_cmp_eq_u32 s43, 2
    s_cselect_b32 s100, 0x54080355, s100
    s_cselect_b32 s101, 0x0, s101
    s_cmp_eq_u32 s43, 3
    s_cselect_b32 s100, 0x50200d55, s100
    s_cselect_b32 s101, 0x0, s101
    s_add_u32 s4, s92, 0x3ff000
    s_addc_u32 s5, s93, 0
    s_mov_b32 s6, 0x401000
    s_mov_b32 s7, 0x20000
    s_mov_b32 s8, s80
    s_mov_b32 s9, s81
    s_mov_b32 s10, 0x200000
    s_mov_b32 s11, 0x20000
    s_barrier
    s_mov_b32 s32, 0
    s_mov_b32 s94, 0
    s_mov_b64 s[48:49], s[100:101]
    s_mov_b32 s31, 12
Lwr_16:
    s_and_b32 s95, s100, 1
    s_and_b32 s96, s100, 2
    s_lshl1_add_u32 s95, s96, s95
    s_add_u32 s95, s95, s94
    s_sub_u32 s95, s95, 1
    s_lshr_b64 s[100:101], s[100:101], 2
    s_mul_i32 s96, s95, 131072
    s_mul_i32 s95, s95, 16384
    s_add_u32 s29, s40, s95
    s_add_u32 s30, s41, s96
    s_add_u32 s94, s94, 1
    s_add_u32 m0, s32, s65
    s_nop 0
    buffer_load_dwordx4 v6, s[8:11], s30 offen offset:0  lds
    buffer_load_dwordx4 v7, s[8:11], s30 offen offset:1024  lds
    s_add_u32 s32, s32, 8192
    s_sub_u32 s31, s31, 1
    s_cmp_lg_u32 s31, 0
    s_cbranch_scc1 Lwr_16
    s_and_b32 s95, s100, 1
    s_and_b32 s96, s100, 2
    s_lshl1_add_u32 s95, s96, s95
    s_add_u32 s95, s95, s94
    s_sub_u32 s95, s95, 1
    s_lshr_b64 s[100:101], s[100:101], 2
    s_mul_i32 s96, s95, 131072
    s_mul_i32 s95, s95, 16384
    s_add_u32 s29, s40, s95
    s_add_u32 s30, s41, s96
    s_add_u32 s94, s94, 1
    s_mov_b32 s16, s30
    s_and_b32 s95, s100, 1
    s_and_b32 s96, s100, 2
    s_lshl1_add_u32 s95, s96, s95
    s_add_u32 s95, s95, s94
    s_sub_u32 s95, s95, 1
    s_lshr_b64 s[100:101], s[100:101], 2
    s_mul_i32 s96, s95, 131072
    s_mul_i32 s95, s95, 16384
    s_add_u32 s29, s40, s95
    s_add_u32 s30, s41, s96
    s_add_u32 s94, s94, 1
    s_mov_b32 s17, s30
    s_and_b32 s95, s100, 1
    s_and_b32 s96, s100, 2
    s_lshl1_add_u32 s95, s96, s95
    s_add_u32 s95, s95, s94
    s_sub_u32 s95, s95, 1
    s_lshr_b64 s[100:101], s[100:101], 2
    s_mul_i32 s96, s95, 131072
    s_mul_i32 s95, s95, 16384
    s_add_u32 s29, s40, s95
    s_add_u32 s30, s41, s96
    s_add_u32 s94, s94, 1
    s_mov_b32 s18, s30
    s_and_b32 s95, s100, 1
    s_and_b32 s96, s100, 2
    s_lshl1_add_u32 s95, s96, s95
    s_add_u32 s95, s95, s94
    s_sub_u32 s95, s95, 1
    s_lshr_b64 s[100:101], s[100:101], 2
    s_mul_i32 s96, s95, 131072
    s_mul_i32 s95, s95, 16384
    s_add_u32 s29, s40, s95
    s_add_u32 s30, s41, s96
    s_add_u32 s94, s94, 1
    s_mov_b32 s19, s30
    s_mov_b64 s[100:101], s[48:49]
    s_add_u32 s20, s92, 0x1f00000
    s_addc_u32 s21, s93, 0
    s_mov_b32 s22, 0x38000
    s_mov_b32 s23, 0x20000
    s_lshl_b32 s35, s55, 13
    s_add_u32 s35, s35, 131072
    v_xor_b32 v28, 0, v24
    v_add_u32 v28, s35, v28
    v_xor_b32 v29, 32, v24
    v_add_u32 v29, s35, v29
    v_xor_b32 v30, 64, v24
    v_add_u32 v30, s35, v30
    v_xor_b32 v31, 96, v24
    v_add_u32 v31, s35, v31
    v_mov_b32 v32, 0
    v_mov_b32 v33, 0
    v_mov_b32 v34, 0
    v_mov_b32 v35, 0
    v_mov_b32 v36, 0
    v_mov_b32 v37, 0
    v_mov_b32 v38, 0
    v_mov_b32 v39, 0
    s_mov_b32 s70, 0x3f803f80
    s_waitcnt vmcnt(24)
    ds_read_b64_tr_b16 v[48:49], v28 offset:0
    ds_read_b64_tr_b16 v[50:51], v29 offset:0
    ds_read_b64_tr_b16 v[52:53], v30 offset:0
    ds_read_b64_tr_b16 v[54:55], v31 offset:0
    ds_read_b64_tr_b16 v[56:57], v28 offset:2048
    ds_read_b64_tr_b16 v[58:59], v29 offset:2048
    ds_read_b64_tr_b16 v[60:61], v30 offset:2048
    ds_read_b64_tr_b16 v[62:63], v31 offset:2048
    ds_read_b64_tr_b16 v[64:65], v28 offset:4096
    ds_read_b64_tr_b16 v[66:67], v29 offset:4096
    ds_read_b64_tr_b16 v[68:69], v30 offset:4096
    ds_read_b64_tr_b16 v[70:71], v31 offset:4096
    ds_read_b64_tr_b16 v[72:73], v28 offset:6144
    ds_read_b64_tr_b16 v[74:75], v29 offset:6144
    ds_read_b64_tr_b16 v[76:77], v30 offset:6144
    ds_read_b64_tr_b16 v[78:79], v31 offset:6144
    s_waitcnt lgkmcnt(0)
    v_dot2c_f32_bf16 v32, s70, v48
    v_dot2c_f32_bf16 v33, s70, v49
    v_dot2c_f32_bf16 v34, s70, v50
    v_dot2c_f32_bf16 v35, s70, v51
    v_dot2c_f32_bf16 v36, s70, v52
    v_dot2c_f32_bf16 v37, s70, v53
    v_dot2c_f32_bf16 v38, s70, v54
    v_dot2c_f32_bf16 v39, s70, v55
    v_dot2c_f32_bf16 v32, s70, v56
    v_dot2c_f32_bf16 v33, s70, v57
    v_dot2c_f32_bf16 v34, s70, v58
    v_dot2c_f32_bf16 v35, s70, v59
    v_dot2c_f32_bf16 v36, s70, v60
    v_dot2c_f32_bf16 v37, s70, v61
    v_dot2c_f32_bf16 v38, s70, v62
    v_dot2c_f32_bf16 v39, s70, v63
    v_dot2c_f32_bf16 v32, s70, v64
    v_dot2c_f32_bf16 v33, s70, v65
    v_dot2c_f32_bf16 v34, s70, v66
    v_dot2c_f32_bf16 v35, s70, v67
    v_dot2c_f32_bf16 v36, s70, v68
    v_dot2c_f32_bf16 v37, s70, v69
    v_dot2c_f32_bf16 v38, s70, v70
    v_dot2c_f32_bf16 v39, s70, v71
    v_dot2c_f32_bf16 v32, s70, v72
    v_dot2c_f32_bf16 v33, s70, v73
    v_dot2c_f32_bf16 v34, s70, v74
    v_dot2c_f32_bf16 v35, s70, v75
    v_dot2c_f32_bf16 v36, s70, v76
    v_dot2c_f32_bf16 v37, s70, v77
    v_dot2c_f32_bf16 v38, s70, v78
    v_dot2c_f32_bf16 v39, s70, v79
    s_nop 2
    v_add_f32 v32, v32, v33
    v_add_f32 v34, v34, v35
    v_add_f32 v36, v36, v37
    v_add_f32 v38, v38, v39
    s_nop 1
    v_permlane32_swap_b32 v32, v36
    v_permlane32_swap_b32 v34, v38
    s_nop 0
    v_add_f32 v32, v32, v36
    v_add_f32 v34, v34, v38
    s_nop 1
    v_permlane16_swap_b32 v32, v34
    s_nop 0
    v_add_f32 v32, v32, v34
    s_mul_i32 s34, s46, 14336
    s_lshl_b32 s35, s47, 8
    s_add_u32 s34, s34, s35
    v_lshlrev_b32 v28, 2, v1
    buffer_store_dword v32, v28, s[20:23], s34 offen sc1
    s_mov_b32 s72, s88
    s_mov_b32 s73, s89
    s_mov_b32 s74, 0x400000
    s_mov_b32 s75, 0x20000
    s_lshl_b32 s34, s2, 2
    s_add_u32 s34, s34, s55
    s_lshl_b32 s34, s34, 12
    v_lshlrev_b32 v104, 4, v1
    v_mov_b32 v108, -1
    v_mov_b32 v109, -1
    v_mov_b32 v110, -1
    v_mov_b32 v111, -1
    buffer_store_dwordx4 v[108:111], v104, s[72:75], s34 offen offset:0 sc1
    buffer_store_dwordx4 v[108:111], v104, s[72:75], s34 offen offset:1024 sc1
    buffer_store_dwordx4 v[108:111], v104, s[72:75], s34 offen offset:2048 sc1
    buffer_store_dwordx4 v[108:111], v104, s[72:75], s34 offen offset:3072 sc1
    s_add_u32 s72, s92, 0x2000000
    s_addc_u32 s73, s93, 0
    s_mov_b32 s74, 0x4000
    s_mov_b32 s75, 0x20000
    v_mov_b32 v110, 0
    v_mov_b32 v111, 1
    s_lshl_b32 s44, s25, 8
    s_add_u32 s44, s44, 0
    v_and_b32 v112, 15, v1
    v_lshlrev_b32 v112, 4, v112
    s_cmp_lg_u32 s55, 0
    s_barrier
    s_cbranch_scc1 Lsv_17
    s_mov_b64 exec, 1
    buffer_store_dword v111, v110, s[72:75], s28 offen sc1
    s_mov_b64 exec, -1
Lsv_17:
    s_cmp_lg_u32 s55, 0
    s_cbranch_scc1 Lsw_18
    s_mov_b32 s63, 262144
Lpf_19:
    s_sleep 2
    buffer_load_dword v111, v112, s[72:75], s44 offen sc1
    s_sub_u32 s63, s63, 1
    s_cbranch_scc1 Lpe_20
    s_waitcnt vmcnt(0)
    v_cmp_eq_u32 vcc, 0, v111
    s_cbranch_vccnz Lpf_19
Lpe_20:
Lsw_18:
    s_barrier
    s_mov_b32 s32, 0
    s_mov_b32 s94, 0
    s_and_b32 s95, s100, 1
    s_and_b32 s96, s100, 2
    s_lshl1_add_u32 s95, s96, s95
    s_add_u32 s95, s95, s94
    s_sub_u32 s95, s95, 1
    s_lshr_b64 s[100:101], s[100:101], 2
    s_mul_i32 s96, s95, 131072
    s_mul_i32 s95, s95, 16384
    s_add_u32 s29, s40, s95
    s_add_u32 s30, s41, s96
    s_add_u32 s94, s94, 1
    s_add_u32 m0, s32, s64
    s_nop 0
    buffer_load_dwordx4 v8, s[4:7], s29 offen offset:0 sc1 lds
    buffer_load_dwordx4 v9, s[4:7], s29 offen offset:1024 sc1 lds
    buffer_load_dwordx4 v10, s[4:7], s29 offen offset:2048 sc1 lds
    buffer_load_dwordx4 v11, s[4:7], s29 offen offset:3072 sc1 lds
    s_add_u32 s32, s32, 16384
    s_cmp_eq_u32 s32, 65536
    s_cselect_b32 s32, 0, s32
    s_and_b32 s95, s100, 1
    s_and_b32 s96, s100, 2
    s_lshl1_add_u32 s95, s96, s95
    s_add_u32 s95, s95, s94
    s_sub_u32 s95, s95, 1
    s_lshr_b64 s[100:101], s[100:101], 2
    s_mul_i32 s96, s95, 131072
    s_mul_i32 s95, s95, 16384
    s_add_u32 s29, s40, s95
    s_add_u32 s30, s41, s96
    s_add_u32 s94, s94, 1
    s_add_u32 m0, s32, s64
    s_nop 0
    buffer_load_dwordx4 v8, s[4:7], s29 offen offset:0 sc1 lds
    buffer_load_dwordx4 v9, s[4:7], s29 offen offset:1024 sc1 lds
    buffer_load_dwordx4 v10, s[4:7], s29 offen offset:2048 sc1 lds
    buffer_load_dwordx4 v11, s[4:7], s29 offen offset:3072 sc1 lds
    s_add_u32 s32, s32, 16384
    s_cmp_eq_u32 s32, 65536
    s_cselect_b32 s32, 0, s32
    s_and_b32 s95, s100, 1
    s_and_b32 s96, s100, 2
    s_lshl1_add_u32 s95, s96, s95
    s_add_u32 s95, s95, s94
    s_sub_u32 s95, s95, 1
    s_lshr_b64 s[100:101], s[100:101], 2
    s_mul_i32 s96, s95, 131072
    s_mul_i32 s95, s95, 16384
    s_add_u32 s29, s40, s95
    s_add_u32 s30, s41, s96
    s_add_u32 s94, s94, 1
    s_add_u32 m0, s32, s64
    s_nop 0
    buffer_load_dwordx4 v8, s[4:7], s29 offen offset:0 sc1 lds
    buffer_load_dwordx4 v9, s[4:7], s29 offen offset:1024 sc1 lds
    buffer_load_dwordx4 v10, s[4:7], s29 offen offset:2048 sc1 lds
    buffer_load_dwordx4 v11, s[4:7], s29 offen offset:3072 sc1 lds
    s_add_u32 s32, s32, 16384
    s_cmp_eq_u32 s32, 65536
    s_cselect_b32 s32, 0, s32
    s_and_b32 s95, s100, 1
    s_and_b32 s96, s100, 2
    s_lshl1_add_u32 s95, s96, s95
    s_add_u32 s95, s95, s94
    s_sub_u32 s95, s95, 1
    s_lshr_b64 s[100:101], s[100:101], 2
    s_mul_i32 s96, s95, 131072
    s_mul_i32 s95, s95, 16384
    s_add_u32 s29, s40, s95
    s_add_u32 s30, s41, s96
    s_add_u32 s94, s94, 1
    s_add_u32 m0, s32, s64
    s_nop 0
    buffer_load_dwordx4 v8, s[4:7], s29 offen offset:0 sc1 lds
    buffer_load_dwordx4 v9, s[4:7], s29 offen offset:1024 sc1 lds
    buffer_load_dwordx4 v10, s[4:7], s29 offen offset:2048 sc1 lds
    buffer_load_dwordx4 v11, s[4:7], s29 offen offset:3072 sc1 lds
    s_add_u32 s32, s32, 16384
    s_cmp_eq_u32 s32, 65536
    s_cselect_b32 s32, 0, s32
    s_and_b32 s95, s100, 1
    s_and_b32 s96, s100, 2
    s_lshl1_add_u32 s95, s96, s95
    s_add_u32 s95, s95, s94
    s_sub_u32 s95, s95, 1
    s_lshr_b64 s[100:101], s[100:101], 2
    s_mul_i32 s96, s95, 131072
    s_mul_i32 s95, s95, 16384
    s_add_u32 s29, s40, s95
    s_add_u32 s30, s41, s96
    s_add_u32 s94, s94, 1
    s_add_u32 m0, s32, s64
    s_waitcnt vmcnt(12)
    s_barrier
    s_waitcnt vmcnt(8)
    s_barrier
    s_add_u32 m0, s32, s64
    s_nop 0
    buffer_load_dwordx4 v8, s[4:7], s29 offen offset:0 sc1 lds
    buffer_load_dwordx4 v9, s[4:7], s29 offen offset:1024 sc1 lds
    buffer_load_dwordx4 v10, s[4:7], s29 offen offset:2048 sc1 lds
    buffer_load_dwordx4 v11, s[4:7], s29 offen offset:3072 sc1 lds
    s_add_u32 s32, s32, 16384
    s_cmp_eq_u32 s32, 65536
    s_cselect_b32 s32, 0, s32
    s_and_b32 s95, s100, 1
    s_and_b32 s96, s100, 2
    s_lshl1_add_u32 s95, s96, s95
    s_add_u32 s95, s95, s94
    s_sub_u32 s95, s95, 1
    s_lshr_b64 s[100:101], s[100:101], 2
    s_mul_i32 s96, s95, 131072
    s_mul_i32 s95, s95, 16384
    s_add_u32 s29, s40, s95
    s_add_u32 s30, s41, s96
    s_add_u32 s94, s94, 1
    s_add_u32 m0, s32, s64
    s_add_u32 m0, s65, 0
    s_nop 0
    buffer_load_dwordx4 v6, s[8:11], s16 offen offset:0  lds
    buffer_load_dwordx4 v7, s[8:11], s16 offen offset:1024  lds
    s_waitcnt vmcnt(10)
    s_barrier
    s_add_u32 m0, s32, s64
    s_nop 0
    buffer_load_dwordx4 v8, s[4:7], s29 offen offset:0 sc1 lds
    buffer_load_dwordx4 v9, s[4:7], s29 offen offset:1024 sc1 lds
    buffer_load_dwordx4 v10, s[4:7], s29 offen offset:2048 sc1 lds
    buffer_load_dwordx4 v11, s[4:7], s29 offen offset:3072 sc1 lds
    s_add_u32 s32, s32, 16384
    s_cmp_eq_u32 s32, 65536
    s_cselect_b32 s32, 0, s32
    s_and_b32 s95, s100, 1
    s_and_b32 s96, s100, 2
    s_lshl1_add_u32 s95, s96, s95
    s_add_u32 s95, s95, s94
    s_sub_u32 s95, s95, 1
    s_lshr_b64 s[100:101], s[100:101], 2
    s_mul_i32 s96, s95, 131072
    s_mul_i32 s95, s95, 16384
    s_add_u32 s29, s40, s95
    s_add_u32 s30, s41, s96
    s_add_u32 s94, s94, 1
    s_add_u32 m0, s32, s64
    s_add_u32 m0, s65, 8192
    s_nop 0
    buffer_load_dwordx4 v6, s[8:11], s17 offen offset:0  lds
    buffer_load_dwordx4 v7, s[8:11], s17 offen offset:1024  lds
    s_waitcnt vmcnt(12)
    s_barrier
    s_add_u32 m0, s32, s64
    s_nop 0
    buffer_load_dwordx4 v8, s[4:7], s29 offen offset:0 sc1 lds
    buffer_load_dwordx4 v9, s[4:7], s29 offen offset:1024 sc1 lds
    buffer_load_dwordx4 v10, s[4:7], s29 offen offset:2048 sc1 lds
    buffer_load_dwordx4 v11, s[4:7], s29 offen offset:3072 sc1 lds
    s_add_u32 s32, s32, 16384
    s_cmp_eq_u32 s32, 65536
    s_cselect_b32 s32, 0, s32
    s_and_b32 s95, s100, 1
    s_and_b32 s96, s100, 2
    s_lshl1_add_u32 s95, s96, s95
    s_add_u32 s95, s95, s94
    s_sub_u32 s95, s95, 1
    s_lshr_b64 s[100:101], s[100:101], 2
    s_mul_i32 s96, s95, 131072
    s_mul_i32 s95, s95, 16384
    s_add_u32 s29, s40, s95
    s_add_u32 s30, s41, s96
    s_add_u32 s94, s94, 1
    s_add_u32 m0, s32, s64
    s_add_u32 m0, s65, 16384
    s_nop 0
    buffer_load_dwordx4 v6, s[8:11], s18 offen offset:0  lds
    buffer_load_dwordx4 v7, s[8:11], s18 offen offset:1024  lds
    s_waitcnt vmcnt(14)
    s_barrier
    s_add_u32 m0, s32, s64
    s_nop 0
    buffer_load_dwordx4 v8, s[4:7], s29 offen offset:0 sc1 lds
    buffer_load_dwordx4 v9, s[4:7], s29 offen offset:1024 sc1 lds
    buffer_load_dwordx4 v10, s[4:7], s29 offen offset:2048 sc1 lds
    buffer_load_dwordx4 v11, s[4:7], s29 offen offset:3072 sc1 lds
    s_add_u32 s32, s32, 16384
    s_cmp_eq_u32 s32, 65536
    s_cselect_b32 s32, 0, s32
    s_and_b32 s95, s100, 1
    s_and_b32 s96, s100, 2
    s_lshl1_add_u32 s95, s96, s95
    s_add_u32 s95, s95, s94
    s_sub_u32 s95, s95, 1
    s_lshr_b64 s[100:101], s[100:101], 2
    s_mul_i32 s96, s95, 131072
    s_mul_i32 s95, s95, 16384
    s_add_u32 s29, s40, s95
    s_add_u32 s30, s41, s96
    s_add_u32 s94, s94, 1
    s_add_u32 m0, s32, s64
    s_add_u32 m0, s65, 24576
    s_nop 0
    buffer_load_dwordx4 v6, s[8:11], s19 offen offset:0  lds
    buffer_load_dwordx4 v7, s[8:11], s19 offen offset:1024  lds
    s_waitcnt vmcnt(14)
    s_barrier
    s_add_u32 m0, s32, s64
    s_nop 0
    buffer_load_dwordx4 v8, s[4:7], s29 offen offset:0 sc1 lds
    buffer_load_dwordx4 v9, s[4:7], s29 offen offset:1024 sc1 lds
    buffer_load_dwordx4 v10, s[4:7], s29 offen offset:2048 sc1 lds
    buffer_load_dwordx4 v11, s[4:7], s29 offen offset:3072 sc1 lds
    s_add_u32 s32, s32, 16384
    s_cmp_eq_u32 s32, 65536
    s_cselect_b32 s32, 0, s32
    s_and_b32 s95, s100, 1
    s_and_b32 s96, s100, 2
    s_lshl1_add_u32 s95, s96, s95
    s_add_u32 s95, s95, s94
    s_sub_u32 s95, s95, 1
    s_lshr_b64 s[100:101], s[100:101], 2
    s_mul_i32 s96, s95, 131072
    s_mul_i32 s95, s95, 16384
    s_add_u32 s29, s40, s95
    s_add_u32 s30, s41, s96
    s_add_u32 s94, s94, 1
    s_add_u32 m0, s32, s64
    s_cmp_lg_u32 s55, 0
    s_cbranch_scc1 Lc1f_21
    s_mov_b32 s34, 1
    s_atomic_add s34, s[90:91], 128
Lc1f_21:
    s_waitcnt vmcnt(12)
    s_barrier
    s_add_u32 m0, s32, s64
    s_nop 0
    buffer_load_dwordx4 v8, s[4:7], s29 offen offset:0 sc1 lds
    buffer_load_dwordx4 v9, s[4:7], s29 offen offset:1024 sc1 lds
    buffer_load_dwordx4 v10, s[4:7], s29 offen offset:2048 sc1 lds
    buffer_load_dwordx4 v11, s[4:7], s29 offen offset:3072 sc1 lds
    s_add_u32 s32, s32, 16384
    s_cmp_eq_u32 s32, 65536
    s_cselect_b32 s32, 0, s32
    s_and_b32 s95, s100, 1
    s_and_b32 s96, s100, 2
    s_lshl1_add_u32 s95, s96, s95
    s_add_u32 s95, s95, s94
    s_sub_u32 s95, s95, 1
    s_lshr_b64 s[100:101], s[100:101], 2
    s_mul_i32 s96, s95, 131072
    s_mul_i32 s95, s95, 16384
    s_add_u32 s29, s40, s95
    s_add_u32 s30, s41, s96
    s_add_u32 s94, s94, 1
    s_add_u32 m0, s32, s64
    s_waitcnt vmcnt(10)
    s_barrier
    s_add_u32 m0, s32, s64
    s_nop 0
    buffer_load_dwordx4 v8, s[4:7], s29 offen offset:0 sc1 lds
    buffer_load_dwordx4 v9, s[4:7], s29 offen offset:1024 sc1 lds
    buffer_load_dwordx4 v10, s[4:7], s29 offen offset:2048 sc1 lds
    buffer_load_dwordx4 v11, s[4:7], s29 offen offset:3072 sc1 lds
    s_add_u32 s32, s32, 16384
    s_cmp_eq_u32 s32, 65536
    s_cselect_b32 s32, 0, s32
    s_and_b32 s95, s100, 1
    s_and_b32 s96, s100, 2
    s_lshl1_add_u32 s95, s96, s95
    s_add_u32 s95, s95, s94
    s_sub_u32 s95, s95, 1
    s_lshr_b64 s[100:101], s[100:101], 2
    s_mul_i32 s96, s95, 131072
    s_mul_i32 s95, s95, 16384
    s_add_u32 s29, s40, s95
    s_add_u32 s30, s41, s96
    s_add_u32 s94, s94, 1
    s_add_u32 m0, s32, s64
    s_mov_b32 s31, 5
Lld_22:
    s_waitcnt vmcnt(8)
    s_barrier
    s_add_u32 m0, s32, s64
    s_nop 0
    buffer_load_dwordx4 v8, s[4:7], s29 offen offset:0 sc1 lds
    buffer_load_dwordx4 v9, s[4:7], s29 offen offset:1024 sc1 lds
    buffer_load_dwordx4 v10, s[4:7], s29 offen offset:2048 sc1 lds
    buffer_load_dwordx4 v11, s[4:7], s29 offen offset:3072 sc1 lds
    s_add_u32 s32, s32, 16384
    s_cmp_eq_u32 s32, 65536
    s_cselect_b32 s32, 0, s32
    s_and_b32 s95, s100, 1
    s_and_b32 s96, s100, 2
    s_lshl1_add_u32 s95, s96, s95
    s_add_u32 s95, s95, s94
    s_sub_u32 s95, s95, 1
    s_lshr_b64 s[100:101], s[100:101], 2
    s_mul_i32 s96, s95, 131072
    s_mul_i32 s95, s95, 16384
    s_add_u32 s29, s40, s95
    s_add_u32 s30, s41, s96
    s_add_u32 s94, s94, 1
    s_add_u32 m0, s32, s64
    s_sub_u32 s31, s31, 1
    s_cmp_lg_u32 s31, 0
    s_cbranch_scc1 Lld_22
    s_waitcnt vmcnt(8)
    s_barrier
    s_waitcnt vmcnt(4)
    s_barrier
    s_mov_b32 s16, s76
    s_mov_b32 s17, s77
    s_mov_b32 s18, 0x400000
    s_mov_b32 s19, 0x20000
    v_xor_b32 v5, v4, v3
    v_lshlrev_b32 v30, 11, v2
    v_lshl_add_u32 v30, v5, 4, v30
    v_xor_b32 v31, 64, v30
    v_add_u32 v31, 15360, v31
    v_add_u32 v32, 30720, v30
    v_add_u32 v33, 30720, v31
    s_lshl_b32 s34, s25, 2
    s_add_u32 s34, s34, s55
    s_lshl_b32 s34, s34, 16
    s_lshl_b32 s35, s26, 7
    s_add_u32 s34, s34, s35
    s_lshl_b32 s35, s55, 12
    s_add_u32 m0, s35, 45056
    s_nop 0
    buffer_load_dwordx4 v30, s[16:19], s34 offen offset:0  lds
    buffer_load_dwordx4 v31, s[16:19], s34 offen offset:1024  lds
    buffer_load_dwordx4 v32, s[16:19], s34 offen offset:2048  lds
    buffer_load_dwordx4 v33, s[16:19], s34 offen offset:3072  lds
    s_waitcnt vmcnt(4)
    s_barrier
    s_waitcnt vmcnt(0)
    s_barrier
p3_l:
    s_lshl_b32 s28, s25, 8
    s_lshl_b32 s34, s26, 4
    s_add_u32 s28, s28, s34
    s_add_u32 s28, s28, 4096
    s_and_b32 s34, s2, 7
    s_lshr_b32 s35, s2, 3
    s_lshr_b32 s39, s35, 3
    s_and_b32 s54, s35, 7
    s_lshr_b32 s36, s34, 1
    s_and_b32 s37, s34, 1
    s_lshl_b32 s25, s36, 2
    s_lshl_b32 s26, s37, 3
    s_add_u32 s25, s25, s39
    s_add_u32 s26, s26, s54
    v_xor_b32 v5, v4, v3
    v_lshrrev_b32 v8, 2, v5
    v_lshlrev_b32 v8, 13, v8
    v_and_b32 v5, 3, v5
    v_lshl_add_u32 v8, v5, 4, v8
    v_lshl_add_u32 v8, v2, 6, v8
    v_xor_b32 v9, 0x2000, v8
    v_add_u32 v9, 3584, v9
    v_add_u32 v10, 3072, v8
    v_add_u32 v11, -1024, v9
    v_add_u32 v8, 4096, v8
    s_mul_i32 s29, s25, 262144
    s_lshl_b32 s34, s55, 11
    s_add_u32 s29, s29, s34
    v_and_b32 v5, 1, v4
    v_lshlrev_b32 v5, 1, v5
    v_xor_b32 v5, v5, v3
    v_mul_u32_u24 v6, 7168, v2
    v_lshl_add_u32 v6, v5, 4, v6
    v_xor_b32 v7, 64, v6
    v_add_u32 v7, 56320, v7
    s_and_b32 s35, s26, 1
    s_lshl_b32 s35, s35, 6
    v_add_u32 v6, s35, v6
    v_add_u32 v7, s35, v7
    v_add_u32 v12, 128, v6
    v_add_u32 v13, 128, v7
    v_add_u32 v14, 256, v6
    v_add_u32 v15, 256, v7
    v_lshrrev_b32 v5, 2, v1
    v_mul_u32_u24 v5, 7168, v5
    v_lshrrev_b32 v16, 5, v1
    v_lshlrev_b32 v16, 1, v16
    v_xor_b32 v16, v16, v1
    v_and_b32 v16, 3, v16
    v_lshl_add_u32 v16, v16, 4, v5
    s_bitcmp1_b32 s26, 0
    s_cselect_b32 s35, 0, 384
    v_add_u32 v16, s35, v16
    s_mul_i32 s30, s55, 114688
    s_mul_i32 s34, s26, 448
    s_add_u32 s30, s30, s34
    s_mul_i32 s64, s55, 4096
    s_mul_i32 s65, s55, 2048
    s_add_u32 s65, s65, 16384
    s_mul_i32 s66, s55, 2048
    s_add_u32 s66, s66, 24576
    s_mul_i32 s67, s55, 2048
    s_add_u32 s67, s67, 32768
    s_mul_i32 s68, s55, 1024
    s_add_u32 s68, s68, 40960
    s_mov_b32 s40, s29
    s_mov_b32 s41, s30
    s_add_u32 s43, s39, s54
    s_and_b32 s43, s43, 3
    s_mov_b32 s100, 0x40808035
    s_mov_b32 s101, 0x0
    s_cmp_eq_u32 s43, 1
    s_cselect_b32 s100, 0x20200d5, s100
    s_cselect_b32 s101, 0x0, s101
    s_cmp_eq_u32 s43, 2
    s_cselect_b32 s100, 0x54080355, s100
    s_cselect_b32 s101, 0x0, s101
    s_cmp_eq_u32 s43, 3
    s_cselect_b32 s100, 0x50200d55, s100
    s_cselect_b32 s101, 0x0, s101
    s_add_u32 s4, s92, 0x7ff000
    s_addc_u32 s5, s93, 0
    s_mov_b32 s6, 0x401000
    s_mov_b32 s7, 0x20000
    s_mov_b32 s8, s84
    s_mov_b32 s9, s85
    s_mov_b32 s10, 0x700000
    s_mov_b32 s11, 0x20000
    s_barrier
    s_mov_b32 s32, 0
    s_mov_b32 s94, 0
    s_mov_b32 s95, s94
    s_mul_i32 s96, s95, 458752
    s_mul_i32 s95, s95, 16384
    s_add_u32 s29, s40, s95
    s_add_u32 s30, s41, s96
    s_add_u32 s94, s94, 1
    s_add_u32 m0, s32, s65
    s_nop 0
    buffer_load_dwordx4 v6, s[8:11], s30 offen offset:0  lds
    buffer_load_dwordx4 v7, s[8:11], s30 offen offset:1024  lds
    s_add_u32 m0, s32, s66
    s_nop 0
    buffer_load_dwordx4 v12, s[8:11], s30 offen offset:0  lds
    buffer_load_dwordx4 v13, s[8:11], s30 offen offset:1024  lds
    s_add_u32 m0, s32, s67
    s_nop 0
    buffer_load_dwordx4 v14, s[8:11], s30 offen offset:0  lds
    buffer_load_dwordx4 v15, s[8:11], s30 offen offset:1024  lds
    s_add_u32 m0, s32, s68
    s_nop 0
    buffer_load_dwordx4 v16, s[8:11], s30 offen offset:0  lds
    s_add_u32 s32, s32, 45056
    s_cmp_eq_u32 s32, 135168
    s_cselect_b32 s32, 0, s32
    s_mov_b32 s95, s94
    s_mul_i32 s96, s95, 458752
    s_mul_i32 s95, s95, 16384
    s_add_u32 s29, s40, s95
    s_add_u32 s30, s41, s96
    s_add_u32 s94, s94, 1
    s_add_u32 m0, s32, s65
    s_nop 0
    buffer_load_dwordx4 v6, s[8:11], s30 offen offset:0  lds
    buffer_load_dwordx4 v7, s[8:11], s30 offen offset:1024  lds
    s_add_u32 m0, s32, s66
    s_nop 0
    buffer_load_dwordx4 v12, s[8:11], s30 offen offset:0  lds
    buffer_load_dwordx4 v13, s[8:11], s30 offen offset:1024  lds
    s_add_u32 m0, s32, s67
    s_nop 0
    buffer_load_dwordx4 v14, s[8:11], s30 offen offset:0  lds
    buffer_load_dwordx4 v15, s[8:11], s30 offen offset:1024  lds
    s_add_u32 m0, s32, s68
    s_nop 0
    buffer_load_dwordx4 v16, s[8:11], s30 offen offset:0  lds
    s_add_u32 s32, s32, 45056
    s_cmp_eq_u32 s32, 135168
    s_cselect_b32 s32, 0, s32
    s_add_u32 s16, s92, 0x1f00000
    s_addc_u32 s17, s93, 0
    s_mov_b32 s18, 0x38000
    s_mov_b32 s19, 0x20000
    s_mov_b32 s72, s90
    s_mov_b32 s73, s91
    s_mov_b32 s74, 0x100
    s_mov_b32 s75, 0x20000
    v_mov_b32 v46, 128
    buffer_load_dword v44, v46, s[72:75], 0 offen sc1
    s_waitcnt vmcnt(0)
    s_mov_b32 s63, 262144
Lpo_23:
    v_cmp_gt_u32 vcc, 0x100, v44
    s_cbranch_vccz Lpd_24
    s_sub_u32 s63, s63, 1
    s_cbranch_scc1 Lpd_24
    s_sleep 4
    buffer_load_dword v44, v46, s[72:75], 0 offen sc1
    s_waitcnt vmcnt(0)
    s_branch Lpo_23
Lpd_24:
    s_mul_i32 s44, s26, 896
    s_mul_i32 s45, s55, 224
    v_lshlrev_b32 v31, 2, v1
    s_and_b32 s34, s26, 1
    s_lshl_b32 s34, s34, 7
    s_add_u32 s34, s34, s45
    v_add_u32 v30, s34, v31
    v_subrev_u32 v32, 896, v30
    v_min_u32 v30, v30, v32
    buffer_load_dword v64, v30, s[16:19], s44 offen sc1
    s_add_u32 s44, s44, 14336
    buffer_load_dword v65, v30, s[16:19], s44 offen sc1
    s_add_u32 s44, s44, 14336
    buffer_load_dword v66, v30, s[16:19], s44 offen sc1
    s_add_u32 s44, s44, 14336
    buffer_load_dword v67, v30, s[16:19], s44 offen sc1
    s_add_u32 s44, s44, 14336
    buffer_load_dword v68, v30, s[16:19], s44 offen sc1
    s_add_u32 s44, s44, 14336
    buffer_load_dword v69, v30, s[16:19], s44 offen sc1
    s_add_u32 s44, s44, 14336
    buffer_load_dword v70, v30, s[16:19], s44 offen sc1
    s_add_u32 s44, s44, 14336
    buffer_load_dword v71, v30, s[16:19], s44 offen sc1
    s_add_u32 s44, s44, 14336
    buffer_load_dword v72, v30, s[16:19], s44 offen sc1
    s_add_u32 s44, s44, 14336
    buffer_load_dword v73, v30, s[16:19], s44 offen sc1
    s_add_u32 s44, s44, 14336
    buffer_load_dword v74, v30, s[16:19], s44 offen sc1
    s_add_u32 s44, s44, 14336
    buffer_load_dword v75, v30, s[16:19], s44 offen sc1
    s_add_u32 s44, s44, 14336
    buffer_load_dword v76, v30, s[16:19], s44 offen sc1
    s_add_u32 s44, s44, 14336
    buffer_load_dword v77, v30, s[16:19], s44 offen sc1
    s_add_u32 s44, s44, 14336
    buffer_load_dword v78, v30, s[16:19], s44 offen sc1
    s_add_u32 s44, s44, 14336
    buffer_load_dword v79, v30, s[16:19], s44 offen sc1
    s_add_u32 s45, s45, 136192
    v_add_u32 v31, s45, v31
    s_add_u32 s72, s92, 0x2000000
    s_addc_u32 s73, s93, 0
    s_mov_b32 s74, 0x4000
    s_mov_b32 s75, 0x20000
    v_mov_b32 v110, 0
    v_mov_b32 v111, 1
    s_lshl_b32 s44, s25, 8
    s_add_u32 s44, s44, 4096
    v_and_b32 v112, 15, v1
    v_lshlrev_b32 v112, 4, v112
    s_cmp_lg_u32 s55, 0
    s_barrier
    s_cbranch_scc1 Lsv_25
    s_mov_b64 exec, 1
    buffer_store_dword v111, v110, s[72:75], s28 offen sc1
    s_mov_b64 exec, -1
Lsv_25:
    s_cmp_lg_u32 s55, 0
    s_cbranch_scc1 Lsw_26
    s_mov_b32 s63, 262144
Lpf_27:
    s_sleep 2
    buffer_load_dword v111, v112, s[72:75], s44 offen sc1
    s_sub_u32 s63, s63, 1
    s_cbranch_scc1 Lpe_28
    s_waitcnt vmcnt(0)
    v_cmp_eq_u32 vcc, 0, v111
    s_cbranch_vccnz Lpf_27
Lpe_28:
Lsw_26:
    s_barrier
    s_mov_b32 s32, 0
    s_mov_b32 s94, 0
    s_and_b32 s95, s100, 1
    s_and_b32 s96, s100, 2
    s_lshl1_add_u32 s95, s96, s95
    s_add_u32 s95, s95, s94
    s_sub_u32 s95, s95, 1
    s_lshr_b64 s[100:101], s[100:101], 2
    s_mul_i32 s96, s95, 458752
    s_mul_i32 s95, s95, 16384
    s_add_u32 s29, s40, s95
    s_add_u32 s30, s41, s96
    s_add_u32 s94, s94, 1
    s_add_u32 m0, s32, s64
    s_nop 0
    buffer_load_dwordx4 v8, s[4:7], s29 offen offset:0 sc1 lds
    buffer_load_dwordx4 v9, s[4:7], s29 offen offset:1024 sc1 lds
    buffer_load_dwordx4 v10, s[4:7], s29 offen offset:2048 sc1 lds
    buffer_load_dwordx4 v11, s[4:7], s29 offen offset:3072 sc1 lds
    s_add_u32 s32, s32, 45056
    s_cmp_eq_u32 s32, 135168
    s_cselect_b32 s32, 0, s32
    s_and_b32 s95, s100, 1
    s_and_b32 s96, s100, 2
    s_lshl1_add_u32 s95, s96, s95
    s_add_u32 s95, s95, s94
    s_sub_u32 s95, s95, 1
    s_lshr_b64 s[100:101], s[100:101], 2
    s_mul_i32 s96, s95, 458752
    s_mul_i32 s95, s95, 16384
    s_add_u32 s29, s40, s95
    s_add_u32 s30, s41, s96
    s_add_u32 s94, s94, 1
    s_add_u32 m0, s32, s64
    s_nop 0
    buffer_load_dwordx4 v8, s[4:7], s29 offen offset:0 sc1 lds
    buffer_load_dwordx4 v9, s[4:7], s29 offen offset:1024 sc1 lds
    buffer_load_dwordx4 v10, s[4:7], s29 offen offset:2048 sc1 lds
    buffer_load_dwordx4 v11, s[4:7], s29 offen offset:3072 sc1 lds
    s_add_u32 s32, s32, 45056
    s_cmp_eq_u32 s32, 135168
    s_cselect_b32 s32, 0, s32
    s_and_b32 s95, s100, 1
    s_and_b32 s96, s100, 2
    s_lshl1_add_u32 s95, s96, s95
    s_add_u32 s95, s95, s94
    s_sub_u32 s95, s95, 1
    s_lshr_b64 s[100:101], s[100:101], 2
    s_mul_i32 s96, s95, 458752
    s_mul_i32 s95, s95, 16384
    s_add_u32 s29, s40, s95
    s_add_u32 s30, s41, s96
    s_add_u32 s94, s94, 1
    s_add_u32 m0, s32, s64
    s_add_u32 s20, s92, 0x1c00000
    s_addc_u32 s21, s93, 0
    s_mov_b32 s22, 0x40000
    s_mov_b32 s23, 0x20000
    v_and_b32 v28, 31, v1
    v_lshlrev_b32 v29, 3, v28
    v_lshrrev_b32 v30, 5, v1
    v_lshl_add_u32 v29, v30, 17, v29
    s_lshl_b32 s44, s25, 10
    s_lshl_b32 s34, s55, 8
    s_add_u32 s44, s44, s34
    buffer_load_dwordx2 v[48:49], v29, s[20:23], s44 offen sc1
    s_add_u32 s44, s44, 16384
    buffer_load_dwordx2 v[50:51], v29, s[20:23], s44 offen sc1
    s_add_u32 s44, s44, 16384
    buffer_load_dwordx2 v[52:53], v29, s[20:23], s44 offen sc1
    s_add_u32 s44, s44, 16384
    buffer_load_dwordx2 v[54:55], v29, s[20:23], s44 offen sc1
    s_add_u32 s44, s44, 16384
    buffer_load_dwordx2 v[56:57], v29, s[20:23], s44 offen sc1
    s_add_u32 s44, s44, 16384
    buffer_load_dwordx2 v[58:59], v29, s[20:23], s44 offen sc1
    s_add_u32 s44, s44, 16384
    buffer_load_dwordx2 v[60:61], v29, s[20:23], s44 offen sc1
    s_add_u32 s44, s44, 16384
    buffer_load_dwordx2 v[62:63], v29, s[20:23], s44 offen sc1
    s_waitcnt vmcnt(12)
    s_barrier
    buffer_load_dwordx4 v8, s[4:7], s29 offen offset:0 sc1 lds
    buffer_load_dwordx4 v9, s[4:7], s29 offen offset:1024 sc1 lds
    buffer_load_dwordx4 v10, s[4:7], s29 offen offset:2048 sc1 lds
    buffer_load_dwordx4 v11, s[4:7], s29 offen offset:3072 sc1 lds
    s_add_u32 m0, s32, s65
    s_nop 0
    buffer_load_dwordx4 v6, s[8:11], s30 offen offset:0  lds
    buffer_load_dwordx4 v7, s[8:11], s30 offen offset:1024  lds
    s_add_u32 m0, s32, s66
    s_nop 0
    buffer_load_dwordx4 v12, s[8:11], s30 offen offset:0  lds
    buffer_load_dwordx4 v13, s[8:11], s30 offen offset:1024  lds
    s_add_u32 m0, s32, s67
    s_nop 0
    buffer_load_dwordx4 v14, s[8:11], s30 offen offset:0  lds
    buffer_load_dwordx4 v15, s[8:11], s30 offen offset:1024  lds
    s_add_u32 m0, s32, s68
    s_nop 0
    buffer_load_dwordx4 v16, s[8:11], s30 offen offset:0  lds
    s_add_u32 s32, s32, 45056
    s_cmp_eq_u32 s32, 135168
    s_cselect_b32 s32, 0, s32
    s_and_b32 s95, s100, 1
    s_and_b32 s96, s100, 2
    s_lshl1_add_u32 s95, s96, s95
    s_add_u32 s95, s95, s94
    s_sub_u32 s95, s95, 1
    s_lshr_b64 s[100:101], s[100:101], 2
    s_mul_i32 s96, s95, 458752
    s_mul_i32 s95, s95, 16384
    s_add_u32 s29, s40, s95
    s_add_u32 s30, s41, s96
    s_add_u32 s94, s94, 1
    s_add_u32 m0, s32, s64
    s_waitcnt vmcnt(19)
    s_barrier
    buffer_load_dwordx4 v8, s[4:7], s29 offen offset:0 sc1 lds
    buffer_load_dwordx4 v9, s[4:7], s29 offen offset:1024 sc1 lds
    buffer_load_dwordx4 v10, s[4:7], s29 offen offset:2048 sc1 lds
    buffer_load_dwordx4 v11, s[4:7], s29 offen offset:3072 sc1 lds
    s_add_u32 m0, s32, s65
    s_nop 0
    buffer_load_dwordx4 v6, s[8:11], s30 offen offset:0  lds
    buffer_load_dwordx4 v7, s[8:11], s30 offen offset:1024  lds
    s_add_u32 m0, s32, s66
    s_nop 0
    buffer_load_dwordx4 v12, s[8:11], s30 offen offset:0  lds
    buffer_load_dwordx4 v13, s[8:11], s30 offen offset:1024  lds
    s_add_u32 m0, s32, s67
    s_nop 0
    buffer_load_dwordx4 v14, s[8:11], s30 offen offset:0  lds
    buffer_load_dwordx4 v15, s[8:11], s30 offen offset:1024  lds
    s_add_u32 m0, s32, s68
    s_nop 0
    buffer_load_dwordx4 v16, s[8:11], s30 offen offset:0  lds
    s_add_u32 s32, s32, 45056
    s_cmp_eq_u32 s32, 135168
    s_cselect_b32 s32, 0, s32
    s_and_b32 s95, s100, 1
    s_and_b32 s96, s100, 2
    s_lshl1_add_u32 s95, s96, s95
    s_add_u32 s95, s95, s94
    s_sub_u32 s95, s95, 1
    s_lshr_b64 s[100:101], s[100:101], 2
    s_mul_i32 s96, s95, 458752
    s_mul_i32 s95, s95, 16384
    s_add_u32 s29, s40, s95
    s_add_u32 s30, s41, s96
    s_add_u32 s94, s94, 1
    s_add_u32 m0, s32, s64
    s_mov_b32 s31, 11
Lld_29:
    s_waitcnt vmcnt(11)
    s_barrier
    buffer_load_dwordx4 v8, s[4:7], s29 offen offset:0 sc1 lds
    buffer_load_dwordx4 v9, s[4:7], s29 offen offset:1024 sc1 lds
    buffer_load_dwordx4 v10, s[4:7], s29 offen offset:2048 sc1 lds
    buffer_load_dwordx4 v11, s[4:7], s29 offen offset:3072 sc1 lds
    s_add_u32 m0, s32, s65
    s_nop 0
    buffer_load_dwordx4 v6, s[8:11], s30 offen offset:0  lds
    buffer_load_dwordx4 v7, s[8:11], s30 offen offset:1024  lds
    s_add_u32 m0, s32, s66
    s_nop 0
    buffer_load_dwordx4 v12, s[8:11], s30 offen offset:0  lds
    buffer_load_dwordx4 v13, s[8:11], s30 offen offset:1024  lds
    s_add_u32 m0, s32, s67
    s_nop 0
    buffer_load_dwordx4 v14, s[8:11], s30 offen offset:0  lds
    buffer_load_dwordx4 v15, s[8:11], s30 offen offset:1024  lds
    s_add_u32 m0, s32, s68
    s_nop 0
    buffer_load_dwordx4 v16, s[8:11], s30 offen offset:0  lds
    s_add_u32 s32, s32, 45056
    s_cmp_eq_u32 s32, 135168
    s_cselect_b32 s32, 0, s32
    s_and_b32 s95, s100, 1
    s_and_b32 s96, s100, 2
    s_lshl1_add_u32 s95, s96, s95
    s_add_u32 s95, s95, s94
    s_sub_u32 s95, s95, 1
    s_lshr_b64 s[100:101], s[100:101], 2
    s_mul_i32 s96, s95, 458752
    s_mul_i32 s95, s95, 16384
    s_add_u32 s29, s40, s95
    s_add_u32 s30, s41, s96
    s_add_u32 s94, s94, 1
    s_add_u32 m0, s32, s64
    s_sub_u32 s31, s31, 1
    s_cmp_lg_u32 s31, 0
    s_cbranch_scc1 Lld_29
    s_waitcnt vmcnt(11)
    s_barrier
    buffer_load_dwordx4 v8, s[4:7], s29 offen offset:0 sc1 lds
    buffer_load_dwordx4 v9, s[4:7], s29 offen offset:1024 sc1 lds
    buffer_load_dwordx4 v10, s[4:7], s29 offen offset:2048 sc1 lds
    buffer_load_dwordx4 v11, s[4:7], s29 offen offset:3072 sc1 lds
    s_add_u32 m0, s32, s65
    s_nop 0
    buffer_load_dwordx4 v6, s[8:11], s30 offen offset:0  lds
    buffer_load_dwordx4 v7, s[8:11], s30 offen offset:1024  lds
    s_add_u32 m0, s32, s66
    s_nop 0
    buffer_load_dwordx4 v12, s[8:11], s30 offen offset:0  lds
    buffer_load_dwordx4 v13, s[8:11], s30 offen offset:1024  lds
    s_add_u32 m0, s32, s67
    s_nop 0
    buffer_load_dwordx4 v14, s[8:11], s30 offen offset:0  lds
    buffer_load_dwordx4 v15, s[8:11], s30 offen offset:1024  lds
    s_add_u32 m0, s32, s68
    s_nop 0
    buffer_load_dwordx4 v16, s[8:11], s30 offen offset:0  lds
    s_add_u32 s32, s32, 45056
    s_cmp_eq_u32 s32, 135168
    s_cselect_b32 s32, 0, s32
    s_and_b32 s95, s100, 1
    s_and_b32 s96, s100, 2
    s_lshl1_add_u32 s95, s96, s95
    s_add_u32 s95, s95, s94
    s_sub_u32 s95, s95, 1
    s_lshr_b64 s[100:101], s[100:101], 2
    s_mul_i32 s96, s95, 458752
    s_mul_i32 s95, s95, 16384
    s_add_u32 s29, s40, s95
    s_add_u32 s30, s41, s96
    s_add_u32 s94, s94, 1
    s_add_u32 m0, s32, s64
    s_mov_b32 s72, s86
    s_mov_b32 s73, s87
    s_mov_b32 s74, 0x700000
    s_mov_b32 s75, 0x20000
    s_lshl_b32 s34, s2, 2
    s_add_u32 s34, s34, s55
    s_mul_i32 s34, s34, 7168
    v_min_u32 v98, 55, v1
    v_lshlrev_b32 v98, 7, v98
    buffer_load_dword v99, v98, s[72:75], s34 offen
    s_waitcnt vmcnt(12)
    s_barrier
    v_add_f32 v48, v48, v56
    v_add_f32 v49, v49, v57
    v_add_f32 v50, v50, v58
    v_add_f32 v51, v51, v59
    v_add_f32 v52, v52, v60
    v_add_f32 v53, v53, v61
    v_add_f32 v54, v54, v62
    v_add_f32 v55, v55, v63
    v_add_f32 v48, v48, v52
    v_add_f32 v49, v49, v53
    v_add_f32 v50, v50, v54
    v_add_f32 v51, v51, v55
    v_add_f32 v48, v48, v50
    v_add_f32 v49, v49, v51
    s_lshl_b32 s34, s55, 7
    s_add_u32 s34, s34, 135168
    v_mov_b32 v50, v48
    v_mov_b32 v51, v49
    v_lshlrev_b32 v28, 2, v28
    v_add_u32 v28, s34, v28
    v_permlane32_swap_b32 v48, v50
    v_permlane32_swap_b32 v49, v51
    s_nop 0
    v_add_f32 v48, v48, v50
    v_add_f32 v49, v49, v51
    v_mul_f32 v48, 0x3a800000, v48
    v_mul_f32 v49, 0x3a800000, v49
    v_fma_f32 v49, -v48, v48, v49
    v_max_f32 v49, 0, v49
    v_cvt_pk_bf16_f32 v50, v48, v49
    v_lshlrev_b32 v51, 16, v50
    v_and_b32 v49, 0xffff0000, v50
    v_add_f32 v49, 0x3727c5ac, v49
    v_cvt_pk_bf16_f32 v50, v49, v49
    v_and_b32 v49, 0xffff0000, v50
    v_sqrt_f32 v49, v49
    s_nop 0
    v_cvt_pk_bf16_f32 v50, v49, v49
    v_and_b32 v49, 0xffff0000, v50
    v_rcp_f32 v48, v49
    v_sub_f32 v49, 0, v51
    ds_write_b32 v28, v49 offset:512
    ds_write_b32 v28, v48 offset:0
    v_add_f32 v64, v64, v72
    v_add_f32 v65, v65, v73
    v_add_f32 v66, v66, v74
    v_add_f32 v67, v67, v75
    v_add_f32 v68, v68, v76
    v_add_f32 v69, v69, v77
    v_add_f32 v70, v70, v78
    v_add_f32 v71, v71, v79
    v_add_f32 v64, v64, v68
    v_add_f32 v65, v65, v69
    v_add_f32 v66, v66, v70
    v_add_f32 v67, v67, v71
    v_add_f32 v64, v64, v66
    v_add_f32 v65, v65, v67
    v_add_f32 v64, v64, v65
    s_mov_b32 exec_hi, 0xffffff
    ds_write_b32 v31, v64
    s_mov_b32 exec_hi, -1
    s_waitcnt lgkmcnt(0)
    s_waitcnt vmcnt(1)
    s_barrier
    s_barrier
p4_l:
    s_lshl_b32 s28, s25, 8
    s_lshl_b32 s34, s26, 4
    s_add_u32 s28, s28, s34
    s_add_u32 s28, s28, 8192
    s_and_b32 s34, s2, 7
    s_lshr_b32 s35, s2, 3
    s_lshr_b32 s39, s35, 3
    s_and_b32 s54, s35, 7
    s_and_b32 s3, s34, 1
    s_lshr_b32 s25, s34, 1
    s_lshl2_add_u32 s25, s25, s39
    s_mov_b32 s26, s54
    v_xor_b32 v5, v4, v3
    v_lshrrev_b32 v8, 2, v5
    v_lshlrev_b32 v8, 13, v8
    v_and_b32 v5, 3, v5
    v_lshl_add_u32 v8, v5, 4, v8
    v_lshl_add_u32 v8, v2, 6, v8
    v_xor_b32 v9, 0x2000, v8
    v_add_u32 v9, 3584, v9
    v_add_u32 v10, 3072, v8
    v_add_u32 v11, -1024, v9
    v_add_u32 v8, 4096, v8
    s_mul_i32 s29, s25, 917504
    s_lshl_b32 s34, s55, 11
    s_add_u32 s29, s29, s34
    v_and_b32 v5, 1, v4
    v_lshlrev_b32 v5, 1, v5
    v_xor_b32 v5, v5, v3
    v_mul_u32_u24 v6, 2048, v2
    v_lshl_add_u32 v6, v5, 4, v6
    v_xor_b32 v7, 64, v6
    v_add_u32 v7, 15360, v7
    v_add_u32 v12, 128, v6
    v_add_u32 v13, 128, v7
    s_mul_i32 s30, s55, 32768
    s_mul_i32 s34, s26, 256
    s_add_u32 s30, s30, s34
    s_mul_i32 s34, s3, 458752
    s_add_u32 s29, s29, s34
    s_mul_i32 s34, s3, 3670016
    s_add_u32 s30, s30, s34
    s_mul_i32 s64, s55, 4096
    s_mul_i32 s65, s55, 2048
    s_add_u32 s65, s65, 16384
    s_mul_i32 s66, s55, 2048
    s_add_u32 s66, s66, 24576
    s_mov_b32 s40, s29
    s_mov_b32 s41, s30
    s_add_u32 s43, s39, s54
    s_and_b32 s43, s43, 3
    s_mov_b32 s100, 0x80808035
    s_mov_b32 s101, 0x408080
    s_cmp_eq_u32 s43, 1
    s_cselect_b32 s100, 0x20200d5, s100
    s_cselect_b32 s101, 0x20202, s101
    s_cmp_eq_u32 s43, 2
    s_cselect_b32 s100, 0x8080355, s100
    s_cselect_b32 s101, 0x540808, s101
    s_cmp_eq_u32 s43, 3
    s_cselect_b32 s100, 0x20200d55, s100
    s_cselect_b32 s101, 0x502020, s101
    s_add_u32 s4, s92, 0xbff000
    s_addc_u32 s5, s93, 0
    s_mov_b32 s6, 0xe01000
    s_mov_b32 s7, 0x20000
    s_mov_b32 s8, s86
    s_mov_b32 s9, s87
    s_mov_b32 s10, 0x700000
    s_mov_b32 s11, 0x20000
    s_barrier
    s_mov_b32 s32, 0
    s_mov_b32 s94, 0
    s_add_u32 s72, s92, 0x2000000
    s_addc_u32 s73, s93, 0
    s_mov_b32 s74, 0x4000
    s_mov_b32 s75, 0x20000
    v_mov_b32 v110, 0
    v_mov_b32 v111, 1
    s_lshl_b32 s44, s25, 8
    s_add_u32 s44, s44, 8192
    s_lshl_b32 s35, s3, 7
    s_add_u32 s44, s44, s35
    v_and_b32 v112, 7, v1
    v_lshlrev_b32 v112, 4, v112
    s_cmp_lg_u32 s55, 0
    s_barrier
    s_cbranch_scc1 Lsv_30
    s_mov_b64 exec, 1
    buffer_store_dword v111, v110, s[72:75], s28 offen sc1
    s_mov_b64 exec, -1
Lsv_30:
    s_mov_b32 s95, s94
    s_mul_i32 s96, s95, 131072
    s_mul_i32 s95, s95, 16384
    s_add_u32 s29, s40, s95
    s_add_u32 s30, s41, s96
    s_add_u32 s94, s94, 1
    s_add_u32 m0, s32, s65
    s_nop 0
    buffer_load_dwordx4 v6, s[8:11], s30 offen offset:0  lds
    buffer_load_dwordx4 v7, s[8:11], s30 offen offset:1024  lds
    s_add_u32 m0, s32, s66
    s_nop 0
    buffer_load_dwordx4 v12, s[8:11], s30 offen offset:0  lds
    buffer_load_dwordx4 v13, s[8:11], s30 offen offset:1024  lds
    s_add_u32 s32, s32, 32768
    s_cmp_eq_u32 s32, 131072
    s_cselect_b32 s32, 0, s32
    s_mov_b32 s95, s94
    s_mul_i32 s96, s95, 131072
    s_mul_i32 s95, s95, 16384
    s_add_u32 s29, s40, s95
    s_add_u32 s30, s41, s96
    s_add_u32 s94, s94, 1
    s_add_u32 m0, s32, s65
    s_nop 0
    buffer_load_dwordx4 v6, s[8:11], s30 offen offset:0  lds
    buffer_load_dwordx4 v7, s[8:11], s30 offen offset:1024  lds
    s_add_u32 m0, s32, s66
    s_nop 0
    buffer_load_dwordx4 v12, s[8:11], s30 offen offset:0  lds
    buffer_load_dwordx4 v13, s[8:11], s30 offen offset:1024  lds
    s_add_u32 s32, s32, 32768
    s_cmp_eq_u32 s32, 131072
    s_cselect_b32 s32, 0, s32
    s_cmp_lg_u32 s55, 0
    s_cbranch_scc1 Lsw_31
    s_mov_b32 s63, 262144
Lpf_32:
    s_sleep 2
    buffer_load_dword v111, v112, s[72:75], s44 offen sc1
    s_sub_u32 s63, s63, 1
    s_cbranch_scc1 Lpe_33
    s_waitcnt vmcnt(0)
    v_cmp_eq_u32 vcc, 0, v111
    s_cbranch_vccnz Lpf_32
Lpe_33:
Lsw_31:
    s_barrier
    s_mov_b32 s32, 0
    s_mov_b32 s94, 0
    s_and_b32 s95, s100, 1
    s_and_b32 s96, s100, 2
    s_lshl1_add_u32 s95, s96, s95
    s_add_u32 s95, s95, s94
    s_sub_u32 s95, s95, 1
    s_lshr_b64 s[100:101], s[100:101], 2
    s_mul_i32 s96, s95, 131072
    s_mul_i32 s95, s95, 16384
    s_add_u32 s29, s40, s95
    s_add_u32 s30, s41, s96
    s_add_u32 s94, s94, 1
    s_add_u32 m0, s32, s64
    s_nop 0
    buffer_load_dwordx4 v8, s[4:7], s29 offen offset:0 sc1 lds
    buffer_load_dwordx4 v9, s[4:7], s29 offen offset:1024 sc1 lds
    buffer_load_dwordx4 v10, s[4:7], s29 offen offset:2048 sc1 lds
    buffer_load_dwordx4 v11, s[4:7], s29 offen offset:3072 sc1 lds
    s_add_u32 s32, s32, 32768
    s_cmp_eq_u32 s32, 131072
    s_cselect_b32 s32, 0, s32
    s_and_b32 s95, s100, 1
    s_and_b32 s96, s100, 2
    s_lshl1_add_u32 s95, s96, s95
    s_add_u32 s95, s95, s94
    s_sub_u32 s95, s95, 1
    s_lshr_b64 s[100:101], s[100:101], 2
    s_mul_i32 s96, s95, 131072
    s_mul_i32 s95, s95, 16384
    s_add_u32 s29, s40, s95
    s_add_u32 s30, s41, s96
    s_add_u32 s94, s94, 1
    s_add_u32 m0, s32, s64
    s_nop 0
    buffer_load_dwordx4 v8, s[4:7], s29 offen offset:0 sc1 lds
    buffer_load_dwordx4 v9, s[4:7], s29 offen offset:1024 sc1 lds
    buffer_load_dwordx4 v10, s[4:7], s29 offen offset:2048 sc1 lds
    buffer_load_dwordx4 v11, s[4:7], s29 offen offset:3072 sc1 lds
    s_add_u32 s32, s32, 32768
    s_cmp_eq_u32 s32, 131072
    s_cselect_b32 s32, 0, s32
    s_and_b32 s95, s100, 1
    s_and_b32 s96, s100, 2
    s_lshl1_add_u32 s95, s96, s95
    s_add_u32 s95, s95, s94
    s_sub_u32 s95, s95, 1
    s_lshr_b64 s[100:101], s[100:101], 2
    s_mul_i32 s96, s95, 131072
    s_mul_i32 s95, s95, 16384
    s_add_u32 s29, s40, s95
    s_add_u32 s30, s41, s96
    s_add_u32 s94, s94, 1
    s_add_u32 m0, s32, s64
    s_waitcnt vmcnt(4)
    s_barrier
    buffer_load_dwordx4 v8, s[4:7], s29 offen offset:0 sc1 lds
    buffer_load_dwordx4 v9, s[4:7], s29 offen offset:1024 sc1 lds
    buffer_load_dwordx4 v10, s[4:7], s29 offen offset:2048 sc1 lds
    buffer_load_dwordx4 v11, s[4:7], s29 offen offset:3072 sc1 lds
    s_add_u32 m0, s32, s65
    s_nop 0
    buffer_load_dwordx4 v6, s[8:11], s30 offen offset:0  lds
    buffer_load_dwordx4 v7, s[8:11], s30 offen offset:1024  lds
    s_add_u32 m0, s32, s66
    s_nop 0
    buffer_load_dwordx4 v12, s[8:11], s30 offen offset:0  lds
    buffer_load_dwordx4 v13, s[8:11], s30 offen offset:1024  lds
    s_add_u32 s32, s32, 32768
    s_cmp_eq_u32 s32, 131072
    s_cselect_b32 s32, 0, s32
    s_and_b32 s95, s100, 1
    s_and_b32 s96, s100, 2
    s_lshl1_add_u32 s95, s96, s95
    s_add_u32 s95, s95, s94
    s_sub_u32 s95, s95, 1
    s_lshr_b64 s[100:101], s[100:101], 2
    s_mul_i32 s96, s95, 131072
    s_mul_i32 s95, s95, 16384
    s_add_u32 s29, s40, s95
    s_add_u32 s30, s41, s96
    s_add_u32 s94, s94, 1
    s_add_u32 m0, s32, s64
    s_nop 0
    buffer_load_dwordx4 v8, s[4:7], s29 offen offset:0 sc1 lds
    buffer_load_dwordx4 v9, s[4:7], s29 offen offset:1024 sc1 lds
    s_waitcnt vmcnt(10)
    s_barrier
    buffer_load_dwordx4 v10, s[4:7], s29 offen offset:2048 sc1 lds
    buffer_load_dwordx4 v11, s[4:7], s29 offen offset:3072 sc1 lds
    s_add_u32 m0, s32, s65
    s_nop 0
    buffer_load_dwordx4 v6, s[8:11], s30 offen offset:0  lds
    buffer_load_dwordx4 v7, s[8:11], s30 offen offset:1024  lds
    s_add_u32 m0, s32, s66
    s_nop 0
    buffer_load_dwordx4 v12, s[8:11], s30 offen offset:0  lds
    buffer_load_dwordx4 v13, s[8:11], s30 offen offset:1024  lds
    s_add_u32 s32, s32, 32768
    s_cmp_eq_u32 s32, 131072
    s_cselect_b32 s32, 0, s32
    s_and_b32 s95, s100, 1
    s_and_b32 s96, s100, 2
    s_lshl1_add_u32 s95, s96, s95
    s_add_u32 s95, s95, s94
    s_sub_u32 s95, s95, 1
    s_lshr_b64 s[100:101], s[100:101], 2
    s_mul_i32 s96, s95, 131072
    s_mul_i32 s95, s95, 16384
    s_add_u32 s29, s40, s95
    s_add_u32 s30, s41, s96
    s_add_u32 s94, s94, 1
    s_add_u32 m0, s32, s64
    s_nop 0
    buffer_load_dwordx4 v8, s[4:7], s29 offen offset:0 sc1 lds
    buffer_load_dwordx4 v9, s[4:7], s29 offen offset:1024 sc1 lds
    buffer_load_dwordx4 v10, s[4:7], s29 offen offset:2048 sc1 lds
    buffer_load_dwordx4 v11, s[4:7], s29 offen offset:3072 sc1 lds
    s_add_u32 m0, s32, s65
    s_waitcnt vmcnt(12)
    s_barrier
    buffer_load_dwordx4 v6, s[8:11], s30 offen offset:0  lds
    buffer_load_dwordx4 v7, s[8:11], s30 offen offset:1024  lds
    s_add_u32 m0, s32, s66
    s_nop 0
    buffer_load_dwordx4 v12, s[8:11], s30 offen offset:0  lds
    buffer_load_dwordx4 v13, s[8:11], s30 offen offset:1024  lds
    s_add_u32 s32, s32, 32768
    s_cmp_eq_u32 s32, 131072
    s_cselect_b32 s32, 0, s32
    s_and_b32 s95, s100, 1
    s_and_b32 s96, s100, 2
    s_lshl1_add_u32 s95, s96, s95
    s_add_u32 s95, s95, s94
    s_sub_u32 s95, s95, 1
    s_lshr_b64 s[100:101], s[100:101], 2
    s_mul_i32 s96, s95, 131072
    s_mul_i32 s95, s95, 16384
    s_add_u32 s29, s40, s95
    s_add_u32 s30, s41, s96
    s_add_u32 s94, s94, 1
    s_add_u32 m0, s32, s64
    s_nop 0
    buffer_load_dwordx4 v8, s[4:7], s29 offen offset:0 sc1 lds
    buffer_load_dwordx4 v9, s[4:7], s29 offen offset:1024 sc1 lds
    buffer_load_dwordx4 v10, s[4:7], s29 offen offset:2048 sc1 lds
    buffer_load_dwordx4 v11, s[4:7], s29 offen offset:3072 sc1 lds
    s_add_u32 m0, s32, s65
    s_nop 0
    buffer_load_dwordx4 v6, s[8:11], s30 offen offset:0  lds
    buffer_load_dwordx4 v7, s[8:11], s30 offen offset:1024  lds
    s_add_u32 m0, s32, s66
    s_waitcnt vmcnt(14)
    s_barrier
    buffer_load_dwordx4 v12, s[8:11], s30 offen offset:0  lds
    buffer_load_dwordx4 v13, s[8:11], s30 offen offset:1024  lds
    s_add_u32 s32, s32, 32768
    s_cmp_eq_u32 s32, 131072
    s_cselect_b32 s32, 0, s32
    s_and_b32 s95, s100, 1
    s_and_b32 s96, s100, 2
    s_lshl1_add_u32 s95, s96, s95
    s_add_u32 s95, s95, s94
    s_sub_u32 s95, s95, 1
    s_lshr_b64 s[100:101], s[100:101], 2
    s_mul_i32 s96, s95, 131072
    s_mul_i32 s95, s95, 16384
    s_add_u32 s29, s40, s95
    s_add_u32 s30, s41, s96
    s_add_u32 s94, s94, 1
    s_add_u32 m0, s32, s64
    s_nop 0
    buffer_load_dwordx4 v8, s[4:7], s29 offen offset:0 sc1 lds
    buffer_load_dwordx4 v9, s[4:7], s29 offen offset:1024 sc1 lds
    buffer_load_dwordx4 v10, s[4:7], s29 offen offset:2048 sc1 lds
    buffer_load_dwordx4 v11, s[4:7], s29 offen offset:3072 sc1 lds
    s_add_u32 m0, s32, s65
    s_nop 0
    buffer_load_dwordx4 v6, s[8:11], s30 offen offset:0  lds
    buffer_load_dwordx4 v7, s[8:11], s30 offen offset:1024  lds
    s_add_u32 m0, s32, s66
    s_nop 0
    buffer_load_dwordx4 v12, s[8:11], s30 offen offset:0  lds
    buffer_load_dwordx4 v13, s[8:11], s30 offen offset:1024  lds
    s_add_u32 s32, s32, 32768
    s_cmp_eq_u32 s32, 131072
    s_cselect_b32 s32, 0, s32
    s_and_b32 s95, s100, 1
    s_and_b32 s96, s100, 2
    s_lshl1_add_u32 s95, s96, s95
    s_add_u32 s95, s95, s94
    s_sub_u32 s95, s95, 1
    s_lshr_b64 s[100:101], s[100:101], 2
    s_mul_i32 s96, s95, 131072
    s_mul_i32 s95, s95, 16384
    s_add_u32 s29, s40, s95
    s_add_u32 s30, s41, s96
    s_add_u32 s94, s94, 1
    s_add_u32 m0, s32, s64
    s_mov_b32 s31, 21
Lld_34:
    s_waitcnt vmcnt(16)
    s_barrier
    buffer_load_dwordx4 v8, s[4:7], s29 offen offset:0 sc1 lds
    buffer_load_dwordx4 v9, s[4:7], s29 offen offset:1024 sc1 lds
    buffer_load_dwordx4 v10, s[4:7], s29 offen offset:2048 sc1 lds
    buffer_load_dwordx4 v11, s[4:7], s29 offen offset:3072 sc1 lds
    s_add_u32 m0, s32, s65
    s_nop 0
    buffer_load_dwordx4 v6, s[8:11], s30 offen offset:0  lds
    buffer_load_dwordx4 v7, s[8:11], s30 offen offset:1024  lds
    s_add_u32 m0, s32, s66
    s_nop 0
    buffer_load_dwordx4 v12, s[8:11], s30 offen offset:0  lds
    buffer_load_dwordx4 v13, s[8:11], s30 offen offset:1024  lds
    s_add_u32 s32, s32, 32768
    s_cmp_eq_u32 s32, 131072
    s_cselect_b32 s32, 0, s32
    s_and_b32 s95, s100, 1
    s_and_b32 s96, s100, 2
    s_lshl1_add_u32 s95, s96, s95
    s_add_u32 s95, s95, s94
    s_sub_u32 s95, s95, 1
    s_lshr_b64 s[100:101], s[100:101], 2
    s_mul_i32 s96, s95, 131072
    s_mul_i32 s95, s95, 16384
    s_add_u32 s29, s40, s95
    s_add_u32 s30, s41, s96
    s_add_u32 s94, s94, 1
    s_add_u32 m0, s32, s64
    s_sub_u32 s31, s31, 1
    s_cmp_lg_u32 s31, 0
    s_cbranch_scc1 Lld_34
    s_waitcnt vmcnt(16)
    s_barrier
    s_waitcnt vmcnt(8)
    s_barrier
    s_add_u32 s16, s92, 0x7ff000
    s_addc_u32 s17, s93, 0
    s_mov_b32 s18, 0x401000
    s_mov_b32 s19, 0x20000
    v_xor_b32 v5, v4, v3
    v_lshrrev_b32 v30, 2, v5
    v_lshlrev_b32 v30, 13, v30
    v_and_b32 v5, 3, v5
    v_lshl_add_u32 v30, v5, 4, v30
    v_lshl_add_u32 v30, v2, 6, v30
    v_xor_b32 v31, 0x2000, v30
    v_add_u32 v31, 3584, v31
    v_add_u32 v32, 3072, v30
    v_add_u32 v33, -1024, v31
    v_add_u32 v30, 4096, v30
    s_lshl_b32 s34, s25, 3
    s_add_u32 s34, s34, s26
    s_lshl_b32 s34, s34, 1
    s_and_b32 s35, s55, 1
    s_add_u32 s34, s34, s35
    s_lshl_b32 s34, s34, 14
    s_and_b32 s35, s55, 2
    s_add_u32 s35, s35, s3
    s_lshl_b32 s35, s35, 11
    s_add_u32 s34, s34, s35
    s_lshl_b32 s35, s55, 12
    s_add_u32 m0, s35, 131072
    s_nop 0
    buffer_load_dwordx4 v30, s[16:19], s34 offen offset:0 sc1 lds
    buffer_load_dwordx4 v31, s[16:19], s34 offen offset:1024 sc1 lds
    buffer_load_dwordx4 v32, s[16:19], s34 offen offset:2048 sc1 lds
    buffer_load_dwordx4 v33, s[16:19], s34 offen offset:3072 sc1 lds
    s_waitcnt vmcnt(4)
    s_barrier
    s_waitcnt vmcnt(0)
    s_barrier
sequential_preLN__sliding_local_dilated__dense_activation_silu__prompt_kernel_end:
    s_endpgm
sequential_preLN__sliding_local_dilated__dense_activation_silu__prompt_kernel_last:
.section .rodata,"a"
.p2align 6
.amdhsa_kernel sequential_preLN__sliding_local_dilated__dense_activation_silu__prompt_kernel
  .amdhsa_next_free_vgpr 256
  .amdhsa_next_free_sgpr 102
  .amdhsa_accum_offset 168
  .amdhsa_group_segment_fixed_size 0
  .amdhsa_kernarg_size 72
  .amdhsa_user_sgpr_count 2
  .amdhsa_user_sgpr_kernarg_segment_ptr 1
  .amdhsa_system_sgpr_workgroup_id_x 1
  .amdhsa_float_denorm_mode_32 3
.end_amdhsa_kernel
```
